```python
import torch

def _softmax(x, axis=-1):
    return torch.softmax(x, dim=axis)
def _gelu(x):
    return torch.nn.functional.gelu(x, approximate="tanh")
def _silu(x):
    return torch.nn.functional.silu(x)
def _sigmoid(x):
    return torch.sigmoid(x)
def _layernorm(x, axis=-1, eps=1e-5):
    m = x.mean(dim=axis, keepdim=True)
    v = x.var(dim=axis, keepdim=True, unbiased=False)
    return (x - m) / torch.sqrt(v + eps)
def _scatter_add(tgt, idx, src, axis=0):
    return tgt.clone().index_add_(axis, idx, src)
def _segment_sum(src, seg, n):
    out = torch.zeros((n,) + src.shape[1:], dtype=src.dtype)
    return out.index_add_(0, seg, src)
def _pad(x, pw):
    flat = tuple(v for pair in reversed(pw) for v in pair)
    return torch.nn.functional.pad(x, flat)

kernel_name = 'gated_mix__ssm_conv_s5__glu_gated_swiglu__prompt'

def setup_inputs():

    _w = (lambda a: (lambda t: t.to(torch.bfloat16) if t.is_floating_point() else t)(torch.as_tensor(a)))
    def _A_setup():
        B, S, D = 1, 2048, 448
        P = D
        Lambda_re = -0.5 * (lambda _x: torch.exp(torch.as_tensor(_x)))((lambda *s: torch.randn(*s, dtype=torch.bfloat16) * 0.2)(P))
        Lambda_im = (lambda *s: torch.randn(*s, dtype=torch.bfloat16) * 0.4)(P) * 1.0
        B_re = (lambda *s: torch.randn(*s, dtype=torch.bfloat16) * 0.2)(P, D) * (D ** -0.5)
        B_im = (lambda *s: torch.randn(*s, dtype=torch.bfloat16) * 0.2)(P, D) * (D ** -0.5)
        C_re = (lambda *s: torch.randn(*s, dtype=torch.bfloat16) * 0.2)(D, P) * (P ** -0.5)
        C_im = (lambda *s: torch.randn(*s, dtype=torch.bfloat16) * 0.2)(D, P) * (P ** -0.5)
        log_dt = (lambda *s: torch.randn(*s, dtype=torch.bfloat16) * 0.2)(P) * 0.3 - 2.0
        Dskip = (lambda *s: torch.randn(*s, dtype=torch.bfloat16) * 0.05)(D)
        return {
            "x": _w((lambda *s: torch.randn(*s, dtype=torch.bfloat16) * 0.05)(B, S, D)),
            "Lambda_re": _w(Lambda_re),
            "Lambda_im": _w(Lambda_im),
            "B_re": _w(B_re),
            "B_im": _w(B_im),
            "C_re": _w(C_re),
            "C_im": _w(C_im),
            "log_dt": _w(log_dt),
            "Dskip": _w(Dskip),
        }
    _A_in = _A_setup()

    def _B_setup():
        B, S, D, F = 1, 2048, 448, 1792
        return {
            "x": _w((lambda *s: torch.randn(*s, dtype=torch.bfloat16) * 0.05)(B, S, D)),
            "w1": _w((lambda *s: torch.randn(*s, dtype=torch.bfloat16) * 0.8)(D, F) * (2.0 / D) ** 0.5),
            "w3": _w((lambda *s: torch.randn(*s, dtype=torch.bfloat16) * 0.8)(D, F) * (2.0 / D) ** 0.5),
            "w2": _w((lambda *s: torch.randn(*s, dtype=torch.bfloat16) * 0.8)(F, D) * (2.0 / F) ** 0.5),
        }
    _B_in = _B_setup()

    return {
        "A_x": _A_in["x"],
        "A_Lambda_re": _A_in["Lambda_re"],
        "A_Lambda_im": _A_in["Lambda_im"],
        "A_B_re": _A_in["B_re"],
        "A_B_im": _A_in["B_im"],
        "A_C_re": _A_in["C_re"],
        "A_C_im": _A_in["C_im"],
        "A_log_dt": _A_in["log_dt"],
        "A_Dskip": _A_in["Dskip"],
        "B_x": _B_in["x"],
        "B_w1": _B_in["w1"],
        "B_w3": _B_in["w3"],
        "B_w2": _B_in["w2"],
        "gate_w": _w((lambda *s: torch.randn(*s, dtype=torch.bfloat16) * 0.05)(448) * 16.0),
    }

def reference(A_x, A_Lambda_re, A_Lambda_im, A_B_re, A_B_im, A_C_re, A_C_im, A_log_dt, A_Dskip, B_x, B_w1, B_w3, B_w2, gate_w):
    def _A_ref(x, Lambda_re, Lambda_im, B_re, B_im, C_re, C_im, log_dt, Dskip):
        Bsz, L, H = x.shape
        Lam = Lambda_re + 1j * Lambda_im
        Bmat = B_re + 1j * B_im
        Cmat = C_re + 1j * C_im
        dt = torch.exp(log_dt)
        Lam_bar = torch.exp(dt * Lam)
        B_bar = ((Lam_bar - 1.0) / Lam)[:, None] * Bmat
        Bu = torch.einsum("bld,pd->blp", x + 0j, B_bar)
        h = torch.zeros_like(Bu[:, 0, :])
        hs = []
        for t in range(L):
            h = Lam_bar[None, :] * h + Bu[:, t, :]
            hs.append(h)
        hseq = torch.stack(hs, 1)
        y = 2.0 * torch.einsum("blp,dp->bld", hseq, Cmat).real + x * Dskip[None, None, :]
        return y

    def _B_ref(x, w1, w3, w2):
        gate = torch.einsum("bsd,df->bsf", x, w1)
        up = torch.einsum("bsd,df->bsf", x, w3)
        h = _silu(gate) * up
        out = torch.einsum("bsf,fd->bsd", h, w2)
        return out

    x = A_x
    g = _sigmoid((x * gate_w).sum(-1, keepdims=True))
    a = _A_ref(x, A_Lambda_re, A_Lambda_im, A_B_re, A_B_im, A_C_re, A_C_im, A_log_dt, A_Dskip)
    b = _B_ref(x, B_w1, B_w3, B_w2)
    return g * a + (1 - g) * b
```

```asm
; @launch grid=(256,1,1) block=(512,1,1) lds=163840
.amdgcn_target "amdgcn-amd-amdhsa--gfx950"
.text
.globl gated_mix__ssm_conv_s5__glu_gated_swiglu__prompt_kernel
.p2align 8
.type gated_mix__ssm_conv_s5__glu_gated_swiglu__prompt_kernel,@function
gated_mix__ssm_conv_s5__glu_gated_swiglu__prompt_kernel:
    s_cmp_ge_u32 s2, 256
    s_cbranch_scc1 L_end
    s_load_dwordx16 s[4:19], s[0:1], 0
    s_load_dwordx16 s[20:35], s[0:1], 64
    s_load_dwordx2 s[36:37], s[0:1], 128
    s_getpc_b64 s[96:97]
L_pc0:
    v_lshlrev_b32 v254, 7, v0
    v_min_u32 v254, L_end-L_pc0, v254
    s_cmp_ge_u32 s2, 32
    s_cbranch_scc1 L_nopf
    global_load_dword v255, v254, s[96:97]
L_nopf:
    v_lshrrev_b32 v1, 6, v0
    s_nop 0
    v_readfirstlane_b32 s64, v1
    v_and_b32 v0, 63, v0
    s_cmp_lt_u32 s2, 32
    s_cbranch_scc1 L_aux
    s_lshr_b32 s67, s2, 3
    s_sub_u32 s67, s67, 4
    s_and_b32 s68, s67, 3
    s_lshr_b32 s3, s67, 2
    s_and_b32 s65, s2, 3
    s_lshl_b32 s65, s65, 2
    s_add_u32 s65, s65, s68
    s_bfe_u32 s66, s2, 0x10002
    s_mul_i32 s66, s66, 7
    s_add_u32 s66, s66, s3
    s_and_b32 s75, s2, 7
    s_lshl_b32 s75, s75, 2
    s_add_u32 s75, s75, s68
    s_lshl_b32 s70, s64, 10
    s_mul_i32 s73, s65, 114688
    v_lshrrev_b32 v160, 3, v0
    s_lshl_b32 s67, s64, 3
    v_add_u32 v160, s67, v160
    v_and_b32 v162, 7, v0
    v_bfe_u32 v161, v160, 1, 3
    v_xor_b32 v161, v161, v162
    v_lshlrev_b32 v161, 4, v161
    v_lshrrev_b32 v163, 1, v160
    v_xor_b32 v163, v163, v160
    v_and_b32 v163, 4, v163
    v_mul_u32_u24 v163, 3, v163
    v_xor_b32 v164, v163, v160
    v_mul_u32_u24 v1, 896, v164
    v_add_u32 v1, v1, v161
    v_mul_u32_u24 v3, 3584, v160
    v_lshrrev_b32 v163, 2, v0
    v_and_b32 v163, 4, v163
    v_xor_b32 v163, v163, v162
    v_lshl_add_u32 v3, v163, 4, v3
    s_lshl_b32 s67, s66, 8
    v_add_u32 v3, s67, v3
    s_lshr_b32 s39, s64, 2
    s_mul_i32 s74, s66, 28672
    v_and_b32 v165, 15, v164
    s_lshl_b32 s67, s39, 4
    v_add_u32 v165, s67, v165
    v_mul_u32_u24 v2, 896, v165
    v_add_u32 v2, v2, v161
    v_and_b32 v165, 15, v0
    v_lshrrev_b32 v163, 1, v165
    v_xor_b32 v163, v163, v165
    v_and_b32 v163, 4, v163
    v_mul_u32_u24 v163, 3, v163
    v_xor_b32 v165, v163, v165
    s_lshl_b32 s68, s66, 5
    s_add_u32 s67, s67, s68
    v_add_u32 v165, s67, v165
    v_lshlrev_b32 v165, 1, v165
    s_waitcnt lgkmcnt(0)
    global_load_ushort v232, v165, s[6:7]
    global_load_ushort v233, v165, s[8:9]
    global_load_ushort v240, v165, s[18:19]
    s_mov_b32 s40, s4
    s_mov_b32 s41, s5
    s_mov_b32 s42, 1835008
    s_mov_b32 s43, 0x00020000
    s_bitcmp1_b32 s64, 1
    s_cselect_b32 s52, s12, s10
    s_cselect_b32 s53, s13, s11
    s_mov_b32 s54, 401408
    s_mov_b32 s55, 0x00020000
    s_mov_b32 s44, s24
    s_mov_b32 s45, s25
    s_mov_b32 s46, 1605632
    s_mov_b32 s47, 0x00020000
    s_add_u32 m0, s70, 0
    s_add_u32 s67, s73, 0
    buffer_load_dwordx4 v1, s[40:43], s67 offen lds
    s_add_u32 m0, s70, 8192
    s_add_u32 s67, s73, 57344
    buffer_load_dwordx4 v1, s[40:43], s67 offen lds
    s_add_u32 m0, s70, 16384
    s_add_u32 s67, s74, 0
    buffer_load_dwordx4 v2, s[52:55], s67 offen lds
    s_add_u32 m0, s70, 24576
    s_mov_b32 s67, 0
    buffer_load_dwordx4 v3, s[44:47], s67 offen lds
    s_and_b32 s38, s64, 3
    s_lshr_b32 s22, s64, 1
    s_mov_b32 s72, 0
    s_mov_b32 s48, s26
    s_mov_b32 s49, s27
    s_mov_b32 s50, 1605632
    s_mov_b32 s51, 0x00020000
    v_min_u32 v166, 27, v0
    v_mul_u32_u24 v166, 3584, v166
    s_mul_i32 s67, s65, 100352
    s_lshl_b32 s68, s66, 8
    s_add_u32 s67, s67, s68
    s_cmp_eq_u32 s64, 4
    s_cbranch_scc0 L_t1
    buffer_load_dword v168, v166, s[44:47], s67 offen
L_t1:
    s_add_u32 m0, s70, 32768
    s_add_u32 s67, s73, 128
    buffer_load_dwordx4 v1, s[40:43], s67 offen lds
    s_add_u32 m0, s70, 40960
    s_add_u32 s67, s73, 57472
    buffer_load_dwordx4 v1, s[40:43], s67 offen lds
    s_add_u32 m0, s70, 49152
    s_add_u32 s67, s74, 128
    buffer_load_dwordx4 v2, s[52:55], s67 offen lds
    s_add_u32 m0, s70, 57344
    s_mov_b32 s67, 229376
    buffer_load_dwordx4 v3, s[44:47], s67 offen lds
    v_min_u32 v167, 13, v0
    v_lshlrev_b32 v167, 7, v167
    s_mul_i32 s68, s65, 1792
    s_add_u32 s68, s68, s74
    s_and_b32 s69, s64, 5
    s_cmp_eq_u32 s69, 1
    s_cbranch_scc0 L_t3
    buffer_load_dword v168, v167, s[52:55], s68 offen
L_t3:
    v_lshrrev_b32 v161, 5, v0
    v_and_b32 v160, 31, v0
    v_bfe_u32 v162, v0, 1, 3
    v_xor_b32 v162, v162, v161
    v_lshlrev_b32 v162, 4, v162
    v_lshl_add_u32 v162, v160, 7, v162
    s_lshl_b32 s67, s38, 12
    v_add_u32 v4, s67, v162
    s_lshl_b32 s67, s39, 12
    v_add_u32 v8, s67, v162
    v_xor_b32 v5, 32, v4
    v_xor_b32 v9, 32, v8
    v_xor_b32 v6, 64, v4
    v_xor_b32 v10, 64, v8
    v_xor_b32 v7, 96, v4
    v_xor_b32 v11, 96, v8
    v_bfe_u32 v160, v0, 2, 2
    v_lshl_add_u32 v162, v161, 3, v160
    v_lshlrev_b32 v162, 7, v162
    v_lshrrev_b32 v160, 1, v160
    v_lshl_add_u32 v162, v160, 6, v162
    v_bfe_u32 v160, v0, 4, 1
    v_lshl_add_u32 v162, v160, 5, v162
    v_and_b32 v160, 1, v0
    v_lshl_add_u32 v162, v160, 4, v162
    v_bfe_u32 v160, v0, 1, 1
    v_lshl_add_u32 v162, v160, 3, v162
    s_lshl_b32 s67, s39, 6
    v_xor_b32 v12, s67, v162
    s_mov_b32 s56, s36
    s_mov_b32 s57, s37
    s_mov_b32 s58, 11010048
    s_mov_b32 s59, 0x00020000
    s_add_u32 s24, s36, 11083776
    s_addc_u32 s25, s37, 0
    s_mov_b32 s26, 8192
    s_mov_b32 s27, 0x00020000
    s_mov_b32 s8, s34
    s_mov_b32 s9, s35
    s_mov_b32 s10, 256
    s_mov_b32 s11, 0x00020000
    s_mov_b32 s92, s28
    s_mov_b32 s93, s29
    s_mov_b32 s94, 1605632
    s_mov_b32 s95, 0x00020000
    s_lshl_b32 s75, s75, 1
    s_and_b32 s68, s64, 1
    s_add_u32 s75, s75, s68
    s_lshl_b32 s68, s66, 1
    s_add_u32 s68, s68, s39
    s_lshl_b32 s69, s68, 11
    s_add_u32 s69, s69, 11026432
    s_add_u32 s60, s36, s69
    s_addc_u32 s61, s37, 0
    s_mov_b32 s62, 2048
    s_mov_b32 s63, 0x00020000
    s_lshl_b32 s69, s65, 2
    s_add_u32 s69, s69, s38
    s_mul_i32 s71, s69, 172032
    v_and_b32 v160, 31, v0
    v_lshrrev_b32 v163, 1, v160
    v_xor_b32 v163, v163, v160
    v_and_b32 v163, 4, v163
    v_mul_u32_u24 v163, 3, v163
    v_xor_b32 v160, v163, v160
    v_lshlrev_b32 v13, 4, v160
    v_lshl_add_u32 v13, v161, 9, v13
    v_and_b32 v160, 15, v0
    v_lshlrev_b32 v14, 4, v160
    v_lshl_add_u32 v14, v161, 9, v14
    v_bfe_u32 v162, v0, 4, 1
    v_mul_u32_u24 v162, 28672, v162
    v_add_u32 v14, v162, v14
    s_add_u32 s68, s68, 112
    s_lshl_b32 s68, s68, 10
    v_add_u32 v14, s68, v14
    s_lshl_b32 s68, s66, 2
    s_add_u32 s68, s68, s39
    s_lshl_b32 s68, s68, 11
    v_add_u32 v13, s68, v13
    v_lshlrev_b32 v160, 3, v160
    s_mul_i32 s68, s39, 7
    s_add_u32 s68, s68, s38
    s_lshl_b32 s68, s68, 7
    s_add_u32 s68, s68, 155648
    v_add_u32 v15, s68, v160
    v_mov_b32 v164, 0
    v_mov_b32 v165, 0
    ds_write_b64 v15, v[164:165]
    s_sub_u32 s68, 16, s65
    s_lshl_b32 s68, s68, 7
    v_add_u32 v250, s68, v160
    v_lshrrev_b32 v162, 4, v0
    v_lshl_add_u32 v250, v162, 9, v250
    s_mov_b32 s18, 0
    s_mov_b32 s19, -1
    s_mov_b32 s101, 0xbfb8aa3b
    s_mul_i32 s68, s75, 168
    s_add_u32 s68, s68, s22
    s_lshl_b32 s68, s68, 10
    s_and_b32 s69, s22, 1
    s_lshl_b32 s69, s69, 4
    v_xor_b32 v253, s69, v0
    v_lshl_add_u32 v253, v253, 4, s68
    v_min_u32 v251, 13, v0
    s_lshr_b32 s68, s75, 2
    s_lshl_b32 s68, s68, 7
    v_lshl_add_u32 v251, v251, 2, s68
    s_lshl_b32 s69, s65, 7
    s_lshl_b32 s68, s66, 2
    s_add_u32 s69, s69, s68
    s_cmp_lg_u32 s64, 7
    s_cbranch_scc1 L_o1
    v_mov_b32 v251, s69
L_o1:
    s_waitcnt vmcnt(10)
    v_lshlrev_b32 v232, 16, v232
    s_waitcnt vmcnt(9)
    v_lshlrev_b32 v233, 16, v233
    s_waitcnt vmcnt(8)
    v_lshlrev_b32 v240, 16, v240
    v_mul_f32 v240, 1069066811, v240
    v_exp_f32 v240, v240
    s_nop 0
    v_cvt_pk_bf16_f32 v240, v240, v240
    v_lshlrev_b32 v240, 16, v240
    v_mul_f32 v248, v240, v232
    v_mul_f32 v249, v240, v233
    v_mul_f32 v248, 1069066811, v248
    v_mul_f32 v249, 1042479491, v249
    v_mul_f32 v242, 1.0, v248
    v_mul_f32 v243, 1.0, v249
    v_exp_f32 v242, v242
    v_fract_f32 v243, v243
    v_cos_f32 v224, v243
    v_sin_f32 v225, v243
    v_mul_f32 v224, v242, v224
    v_mul_f32 v225, v242, v225
    v_add_f32 v246, -1.0, v224
    v_mul_f32 v247, v232, v232
    v_fmac_f32 v247, v233, v233
    v_rcp_f32 v247, v247
    v_mul_f32 v238, v246, v232
    v_fmac_f32 v238, v225, v233
    v_mul_f32 v239, v225, v232
    v_fma_f32 v239, -v246, v233, v239
    v_add_f32 v247, v247, v247
    v_mul_f32 v238, v238, v247
    v_mul_f32 v239, v239, v247
    v_mul_f32 v242, 0x41000000, v248
    v_mul_f32 v243, 0x41000000, v249
    v_exp_f32 v242, v242
    v_fract_f32 v243, v243
    v_cos_f32 v226, v243
    v_sin_f32 v227, v243
    v_mul_f32 v226, v242, v226
    v_mul_f32 v227, v242, v227
    v_mul_f32 v228, v226, v226
    v_mul_f32 v229, v226, v227
    v_fma_f32 v228, -v227, v227, v228
    v_add_f32 v229, v229, v229
    v_mul_f32 v230, v228, v228
    v_mul_f32 v231, v228, v229
    v_fma_f32 v230, -v229, v229, v230
    v_add_f32 v231, v231, v231
    v_mul_f32 v242, 0x43000000, v248
    v_mul_f32 v243, 0x43000000, v249
    v_exp_f32 v242, v242
    v_fract_f32 v243, v243
    v_cos_f32 v232, v243
    v_sin_f32 v233, v243
    v_mul_f32 v232, v242, v232
    v_mul_f32 v233, v242, v233
    v_bfe_u32 v244, v0, 4, 1
    v_lshlrev_b32 v244, 4, v244
    v_lshrrev_b32 v245, 5, v0
    v_lshl_add_u32 v245, v245, 3, v244
    v_cvt_f32_u32 v244, v245
    v_mul_f32 v242, v244, v248
    v_mul_f32 v243, v244, v249
    v_exp_f32 v242, v242
    v_fract_f32 v243, v243
    v_cos_f32 v234, v243
    v_sin_f32 v235, v243
    v_mul_f32 v234, v242, v234
    v_mul_f32 v235, v242, v235
    s_lshl_b32 s68, s38, 5
    v_add_u32 v244, s68, v245
    v_cvt_f32_u32 v244, v244
    v_mul_f32 v242, v244, v248
    v_mul_f32 v243, v244, v249
    v_exp_f32 v242, v242
    v_fract_f32 v243, v243
    v_cos_f32 v246, v243
    v_sin_f32 v247, v243
    v_mul_f32 v246, v242, v246
    v_mul_f32 v247, v242, v247
    v_mul_f32 v236, v238, v246
    v_mul_f32 v237, v238, v247
    v_fma_f32 v236, -v239, v247, v236
    v_fmac_f32 v237, v239, v246
    v_lshrrev_b32 v244, 4, v0
    v_lshlrev_b32 v244, 9, v244
    v_cvt_f32_u32 v244, v244
    v_mul_f32 v242, v244, v248
    v_mul_f32 v243, v244, v249
    v_exp_f32 v242, v242
    v_fract_f32 v243, v243
    v_cos_f32 v240, v243
    v_sin_f32 v241, v243
    v_mul_f32 v240, v242, v240
    v_mul_f32 v241, v242, v241
    v_and_b32 v254, 31, v0
    v_lshrrev_b32 v255, 5, v0
    v_lshlrev_b32 v255, 3, v255
    v_sub_u32 v254, v254, v255
    v_and_b32 v255, 1, v254
    v_lshlrev_b32 v255, 4, v255
    v_mov_b32 v242, 0x3f80
    v_lshlrev_b32 v255, v255, v242
    v_ashrrev_i32 v254, 1, v254
    v_cmp_eq_u32 vcc, 0, v254
    v_cmp_eq_u32 s[6:7], 1, v254
    s_nop 0
    v_cndmask_b32 v242, 0, v255, vcc
    v_cndmask_b32 v243, 0, v255, s[6:7]
    v_cmp_eq_u32 vcc, 2, v254
    v_cmp_eq_u32 s[6:7], 3, v254
    s_nop 0
    v_cndmask_b32 v244, 0, v255, vcc
    v_cndmask_b32 v245, 0, v255, s[6:7]
    v_cmp_eq_u32 vcc, 8, v254
    v_cmp_eq_u32 s[6:7], 9, v254
    s_nop 0
    v_cndmask_b32 v246, 0, v255, vcc
    v_cndmask_b32 v247, 0, v255, s[6:7]
    v_cmp_eq_u32 vcc, 10, v254
    v_cmp_eq_u32 s[6:7], 11, v254
    s_nop 0
    v_cndmask_b32 v248, 0, v255, vcc
    v_cndmask_b32 v249, 0, v255, s[6:7]
    s_mov_b32 s6, 0xffff0000
    s_mov_b32 s7, 0xffff0000
    s_waitcnt vmcnt(4)
    s_barrier
    ds_read_b128 v[16:19], v4 offset:0
    ds_read_b128 v[192:195], v8 offset:16384
    ds_read_b64_tr_b16 v[196:197], v12 offset:24576
    ds_read_b64_tr_b16 v[198:199], v12 offset:25088
    ds_read_b128 v[20:23], v5 offset:0
    ds_read_b128 v[200:203], v9 offset:16384
    ds_read_b64_tr_b16 v[204:205], v12 offset:26624
    ds_read_b64_tr_b16 v[206:207], v12 offset:27136
    ds_read_b128 v[24:27], v6 offset:0
    ds_read_b128 v[208:211], v10 offset:16384
    ds_read_b64_tr_b16 v[212:213], v12 offset:28672
    ds_read_b64_tr_b16 v[214:215], v12 offset:29184
    ds_read_b128 v[28:31], v7 offset:0
    ds_read_b128 v[216:219], v11 offset:16384
    s_waitcnt lgkmcnt(12)
    v_mfma_f32_32x32x16_bf16 v[128:143], v[16:19], v[192:195], 0
    s_add_u32 m0, s70, 65536
    s_add_u32 s67, s73, 256
    buffer_load_dwordx4 v1, s[40:43], s67 offen lds
    ds_read_b64_tr_b16 v[220:221], v12 offset:30720
    ds_read_b64_tr_b16 v[222:223], v12 offset:31232
    s_waitcnt lgkmcnt(12)
    v_mfma_f32_32x32x16_bf16 v[144:159], v[196:199], v[16:19], 0
    s_add_u32 m0, s70, 73728
    s_add_u32 s67, s73, 57600
    buffer_load_dwordx4 v1, s[40:43], s67 offen lds
    s_waitcnt vmcnt(2)
    s_waitcnt lgkmcnt(0)
    s_barrier
    ds_read_b128 v[32:35], v4 offset:32768
    ds_read_b128 v[192:195], v8 offset:49152
    v_mfma_f32_32x32x16_bf16 v[128:143], v[20:23], v[200:203], v[128:143]
    s_add_u32 m0, s70, 81920
    s_add_u32 s67, s74, 256
    buffer_load_dwordx4 v2, s[52:55], s67 offen lds
    ds_read_b64_tr_b16 v[196:197], v12 offset:57344
    ds_read_b64_tr_b16 v[198:199], v12 offset:57856
    v_mfma_f32_32x32x16_bf16 v[144:159], v[204:207], v[20:23], v[144:159]
    s_add_u32 m0, s70, 90112
    s_mov_b32 s67, 458752
    buffer_load_dwordx4 v3, s[44:47], s67 offen lds
    ds_read_b128 v[36:39], v5 offset:32768
    ds_read_b128 v[200:203], v9 offset:49152
    v_mfma_f32_32x32x16_bf16 v[128:143], v[24:27], v[208:211], v[128:143]
    s_add_u32 m0, s70, 98304
    s_add_u32 s67, s73, 384
    buffer_load_dwordx4 v1, s[40:43], s67 offen lds
    ds_read_b64_tr_b16 v[204:205], v12 offset:59392
    ds_read_b64_tr_b16 v[206:207], v12 offset:59904
    v_mfma_f32_32x32x16_bf16 v[144:159], v[212:215], v[24:27], v[144:159]
    s_add_u32 m0, s70, 106496
    s_add_u32 s67, s73, 57728
    buffer_load_dwordx4 v1, s[40:43], s67 offen lds
    ds_read_b128 v[40:43], v6 offset:32768
    ds_read_b128 v[208:211], v10 offset:49152
    v_mfma_f32_32x32x16_bf16 v[128:143], v[28:31], v[216:219], v[128:143]
    s_add_u32 m0, s70, 114688
    s_add_u32 s67, s74, 384
    buffer_load_dwordx4 v2, s[52:55], s67 offen lds
    ds_read_b64_tr_b16 v[212:213], v12 offset:61440
    ds_read_b64_tr_b16 v[214:215], v12 offset:61952
    v_mfma_f32_32x32x16_bf16 v[144:159], v[220:223], v[28:31], v[144:159]
    s_add_u32 m0, s70, 122880
    s_mov_b32 s67, 688128
    buffer_load_dwordx4 v3, s[44:47], s67 offen lds
    ds_read_b128 v[44:47], v7 offset:32768
    ds_read_b128 v[216:219], v11 offset:49152
    s_waitcnt lgkmcnt(12)
    v_mfma_f32_32x32x16_bf16 v[128:143], v[32:35], v[192:195], v[128:143]
    ds_read_b64_tr_b16 v[220:221], v12 offset:63488
    ds_read_b64_tr_b16 v[222:223], v12 offset:64000
    s_waitcnt lgkmcnt(12)
    v_mfma_f32_32x32x16_bf16 v[144:159], v[196:199], v[32:35], v[144:159]
    s_waitcnt vmcnt(4)
    s_barrier
    v_add_u32 v4, 49152, v4
    v_add_u32 v8, 49152, v8
    ds_read_b128 v[48:51], v4 offset:16384
    ds_read_b128 v[192:195], v8 offset:32768
    s_waitcnt lgkmcnt(12)
    v_mfma_f32_32x32x16_bf16 v[128:143], v[36:39], v[200:203], v[128:143]
    s_add_u32 m0, s70, 131072
    s_add_u32 s67, s73, 512
    buffer_load_dwordx4 v1, s[40:43], s67 offen lds
    v_add_u32 v12, 49152, v12
    ds_read_b64_tr_b16 v[196:197], v12 offset:40960
    ds_read_b64_tr_b16 v[198:199], v12 offset:41472
    s_waitcnt lgkmcnt(12)
    v_mfma_f32_32x32x16_bf16 v[144:159], v[204:207], v[36:39], v[144:159]
    s_add_u32 m0, s70, 139264
    s_add_u32 s67, s73, 57856
    buffer_load_dwordx4 v1, s[40:43], s67 offen lds
    v_add_u32 v5, 49152, v5
    v_add_u32 v9, 49152, v9
    ds_read_b128 v[52:55], v5 offset:16384
    ds_read_b128 v[200:203], v9 offset:32768
    s_waitcnt lgkmcnt(12)
    v_mfma_f32_32x32x16_bf16 v[128:143], v[40:43], v[208:211], v[128:143]
    s_add_u32 m0, s70, 0
    s_add_u32 s67, s74, 512
    buffer_load_dwordx4 v2, s[52:55], s67 offen lds
    ds_read_b64_tr_b16 v[204:205], v12 offset:43008
    ds_read_b64_tr_b16 v[206:207], v12 offset:43520
    s_waitcnt lgkmcnt(12)
    v_mfma_f32_32x32x16_bf16 v[144:159], v[212:215], v[40:43], v[144:159]
    s_add_u32 m0, s70, 8192
    s_mov_b32 s67, 917504
    buffer_load_dwordx4 v3, s[44:47], s67 offen lds
    v_add_u32 v6, 49152, v6
    v_add_u32 v10, 49152, v10
    ds_read_b128 v[56:59], v6 offset:16384
    ds_read_b128 v[208:211], v10 offset:32768
    s_waitcnt lgkmcnt(12)
    v_mfma_f32_32x32x16_bf16 v[128:143], v[44:47], v[216:219], v[128:143]
    ds_read_b64_tr_b16 v[212:213], v12 offset:45056
    ds_read_b64_tr_b16 v[214:215], v12 offset:45568
    s_waitcnt lgkmcnt(12)
    v_mfma_f32_32x32x16_bf16 v[144:159], v[220:223], v[44:47], v[144:159]
    v_add_u32 v7, 49152, v7
    v_add_u32 v11, 49152, v11
    ds_read_b128 v[60:63], v7 offset:16384
    ds_read_b128 v[216:219], v11 offset:32768
    s_waitcnt lgkmcnt(12)
    v_mfma_f32_32x32x16_bf16 v[128:143], v[48:51], v[192:195], v[128:143]
    ds_read_b64_tr_b16 v[220:221], v12 offset:47104
    ds_read_b64_tr_b16 v[222:223], v12 offset:47616
    s_waitcnt lgkmcnt(12)
    v_mfma_f32_32x32x16_bf16 v[144:159], v[196:199], v[48:51], v[144:159]
    s_waitcnt vmcnt(4)
    s_barrier
    v_add_u32 v8, 49152, v8
    ds_read_b128 v[64:67], v4 offset:49152
    ds_read_b128 v[192:195], v8 offset:16384
    s_waitcnt lgkmcnt(12)
    v_mfma_f32_32x32x16_bf16 v[128:143], v[52:55], v[200:203], v[128:143]
    s_add_u32 m0, s70, 16384
    s_add_u32 s67, s73, 640
    buffer_load_dwordx4 v1, s[40:43], s67 offen lds
    v_add_u32 v12, 49152, v12
    ds_read_b64_tr_b16 v[196:197], v12 offset:24576
    ds_read_b64_tr_b16 v[198:199], v12 offset:25088
    s_waitcnt lgkmcnt(12)
    v_mfma_f32_32x32x16_bf16 v[144:159], v[204:207], v[52:55], v[144:159]
    s_add_u32 m0, s70, 24576
    s_add_u32 s67, s73, 57984
    buffer_load_dwordx4 v1, s[40:43], s67 offen lds
    v_add_u32 v9, 49152, v9
    ds_read_b128 v[68:71], v5 offset:49152
    ds_read_b128 v[200:203], v9 offset:16384
    s_waitcnt lgkmcnt(12)
    v_mfma_f32_32x32x16_bf16 v[128:143], v[56:59], v[208:211], v[128:143]
    s_add_u32 m0, s70, 32768
    s_add_u32 s67, s74, 640
    buffer_load_dwordx4 v2, s[52:55], s67 offen lds
    ds_read_b64_tr_b16 v[204:205], v12 offset:26624
    ds_read_b64_tr_b16 v[206:207], v12 offset:27136
    s_waitcnt lgkmcnt(12)
    v_mfma_f32_32x32x16_bf16 v[144:159], v[212:215], v[56:59], v[144:159]
    s_add_u32 m0, s70, 40960
    s_mov_b32 s67, 1146880
    buffer_load_dwordx4 v3, s[44:47], s67 offen lds
    v_add_u32 v10, 49152, v10
    ds_read_b128 v[72:75], v6 offset:49152
    ds_read_b128 v[208:211], v10 offset:16384
    s_waitcnt lgkmcnt(12)
    v_mfma_f32_32x32x16_bf16 v[128:143], v[60:63], v[216:219], v[128:143]
    ds_read_b64_tr_b16 v[212:213], v12 offset:28672
    ds_read_b64_tr_b16 v[214:215], v12 offset:29184
    s_waitcnt lgkmcnt(12)
    v_mfma_f32_32x32x16_bf16 v[144:159], v[220:223], v[60:63], v[144:159]
    v_add_u32 v11, 49152, v11
    ds_read_b128 v[76:79], v7 offset:49152
    ds_read_b128 v[216:219], v11 offset:16384
    s_waitcnt lgkmcnt(12)
    v_mfma_f32_32x32x16_bf16 v[128:143], v[64:67], v[192:195], v[128:143]
    ds_read_b64_tr_b16 v[220:221], v12 offset:30720
    ds_read_b64_tr_b16 v[222:223], v12 offset:31232
    s_waitcnt lgkmcnt(12)
    v_mfma_f32_32x32x16_bf16 v[144:159], v[196:199], v[64:67], v[144:159]
    s_waitcnt vmcnt(4)
    s_barrier
    v_add_u32 v4, 49152, v4
    v_add_u32 v8, 4294868992, v8
    ds_read_b128 v[80:83], v4 offset:32768
    ds_read_b128 v[192:195], v8 offset:0
    s_waitcnt lgkmcnt(12)
    v_mfma_f32_32x32x16_bf16 v[128:143], v[68:71], v[200:203], v[128:143]
    s_add_u32 m0, s70, 49152
    s_add_u32 s67, s73, 768
    buffer_load_dwordx4 v1, s[40:43], s67 offen lds
    v_add_u32 v12, 4294868992, v12
    ds_read_b64_tr_b16 v[196:197], v12 offset:8192
    ds_read_b64_tr_b16 v[198:199], v12 offset:8704
    s_waitcnt lgkmcnt(12)
    v_mfma_f32_32x32x16_bf16 v[144:159], v[204:207], v[68:71], v[144:159]
    s_add_u32 m0, s70, 57344
    s_add_u32 s67, s73, 58112
    buffer_load_dwordx4 v1, s[40:43], s67 offen lds
    v_add_u32 v5, 49152, v5
    v_add_u32 v9, 4294868992, v9
    ds_read_b128 v[84:87], v5 offset:32768
    ds_read_b128 v[200:203], v9 offset:0
    s_waitcnt lgkmcnt(12)
    v_mfma_f32_32x32x16_bf16 v[128:143], v[72:75], v[208:211], v[128:143]
    s_add_u32 m0, s70, 65536
    s_add_u32 s67, s74, 768
    buffer_load_dwordx4 v2, s[52:55], s67 offen lds
    v_lshrrev_b32 v170, 3, v0
    s_lshl_b32 s68, s64, 3
    v_add_u32 v170, s68, v170
    ds_read_b64_tr_b16 v[204:205], v12 offset:10240
    ds_read_b64_tr_b16 v[206:207], v12 offset:10752
    s_waitcnt lgkmcnt(12)
    v_mfma_f32_32x32x16_bf16 v[144:159], v[212:215], v[72:75], v[144:159]
    s_add_u32 m0, s70, 73728
    s_mov_b32 s67, 1376256
    buffer_load_dwordx4 v3, s[44:47], s67 offen lds
    v_mul_u32_u24 v170, 896, v170
    v_lshrrev_b32 v171, 2, v0
    v_add_u32 v6, 49152, v6
    v_add_u32 v10, 4294868992, v10
    ds_read_b128 v[88:91], v6 offset:32768
    ds_read_b128 v[208:211], v10 offset:0
    s_waitcnt lgkmcnt(12)
    v_mfma_f32_32x32x16_bf16 v[128:143], v[76:79], v[216:219], v[128:143]
    s_cmp_lg_u32 s64, 5
    s_cbranch_scc1 L_o2
    v_mov_b32 v252, 0
    buffer_load_dword v252, v252, s[8:11], 0 offen sc1
L_o2:
    v_and_b32 v171, 4, v171
    ds_read_b64_tr_b16 v[212:213], v12 offset:12288
    ds_read_b64_tr_b16 v[214:215], v12 offset:12800
    s_waitcnt lgkmcnt(12)
    v_mfma_f32_32x32x16_bf16 v[144:159], v[220:223], v[76:79], v[144:159]
    v_and_b32 v172, 7, v0
    v_xor_b32 v171, v171, v172
    v_add_u32 v7, 49152, v7
    v_add_u32 v11, 4294868992, v11
    ds_read_b128 v[92:95], v7 offset:32768
    ds_read_b128 v[216:219], v11 offset:0
    s_waitcnt lgkmcnt(12)
    v_mfma_f32_32x32x16_bf16 v[128:143], v[80:83], v[192:195], v[128:143]
    v_lshl_add_u32 v2, v171, 4, v170
    s_lshl_b32 s68, s3, 7
    v_add_u32 v2, s68, v2
    ds_read_b64_tr_b16 v[220:221], v12 offset:14336
    ds_read_b64_tr_b16 v[222:223], v12 offset:14848
    s_waitcnt lgkmcnt(12)
    v_mfma_f32_32x32x16_bf16 v[144:159], v[196:199], v[80:83], v[144:159]
    s_waitcnt vmcnt(4)
    s_barrier
    v_add_u32 v4, 4294868992, v4
    ds_read_b128 v[96:99], v4 offset:16384
    ds_read_b128 v[192:195], v8 offset:32768
    s_waitcnt lgkmcnt(12)
    v_mfma_f32_32x32x16_bf16 v[128:143], v[84:87], v[200:203], v[128:143]
    s_add_u32 m0, s70, 81920
    s_mov_b32 s67, 0
    buffer_load_dwordx4 v3, s[48:51], s67 offen lds
    ds_read_b64_tr_b16 v[196:197], v12 offset:40960
    ds_read_b64_tr_b16 v[198:199], v12 offset:41472
    s_waitcnt lgkmcnt(12)
    v_mfma_f32_32x32x16_bf16 v[144:159], v[204:207], v[84:87], v[144:159]
    s_add_u32 m0, s70, 90112
    s_mov_b32 s67, 229376
    buffer_load_dwordx4 v3, s[48:51], s67 offen lds
    v_add_u32 v5, 4294868992, v5
    ds_read_b128 v[100:103], v5 offset:16384
    ds_read_b128 v[200:203], v9 offset:32768
    s_waitcnt lgkmcnt(12)
    v_mfma_f32_32x32x16_bf16 v[128:143], v[88:91], v[208:211], v[128:143]
    s_add_u32 m0, s70, 98304
    s_mov_b32 s67, 458752
    buffer_load_dwordx4 v3, s[48:51], s67 offen lds
    ds_read_b64_tr_b16 v[204:205], v12 offset:43008
    ds_read_b64_tr_b16 v[206:207], v12 offset:43520
    s_waitcnt lgkmcnt(12)
    v_mfma_f32_32x32x16_bf16 v[144:159], v[212:215], v[88:91], v[144:159]
    s_add_u32 m0, s70, 106496
    s_mov_b32 s67, 688128
    buffer_load_dwordx4 v3, s[48:51], s67 offen lds
    v_add_u32 v6, 4294868992, v6
    ds_read_b128 v[104:107], v6 offset:16384
    ds_read_b128 v[208:211], v10 offset:32768
    s_waitcnt lgkmcnt(12)
    v_mfma_f32_32x32x16_bf16 v[128:143], v[92:95], v[216:219], v[128:143]
    ds_read_b64_tr_b16 v[212:213], v12 offset:45056
    ds_read_b64_tr_b16 v[214:215], v12 offset:45568
    s_waitcnt lgkmcnt(12)
    v_mfma_f32_32x32x16_bf16 v[144:159], v[220:223], v[92:95], v[144:159]
    v_add_u32 v7, 4294868992, v7
    ds_read_b128 v[108:111], v7 offset:16384
    ds_read_b128 v[216:219], v11 offset:32768
    s_waitcnt lgkmcnt(12)
    v_mfma_f32_32x32x16_bf16 v[128:143], v[96:99], v[192:195], v[128:143]
    ds_read_b64_tr_b16 v[220:221], v12 offset:47104
    ds_read_b64_tr_b16 v[222:223], v12 offset:47616
    s_waitcnt lgkmcnt(12)
    v_mfma_f32_32x32x16_bf16 v[144:159], v[196:199], v[96:99], v[144:159]
    s_waitcnt vmcnt(4)
    s_barrier
    v_add_u32 v8, 49152, v8
    ds_read_b128 v[112:115], v4 offset:49152
    ds_read_b128 v[192:195], v8 offset:16384
    s_waitcnt lgkmcnt(12)
    v_mfma_f32_32x32x16_bf16 v[128:143], v[100:103], v[200:203], v[128:143]
    s_add_u32 m0, s70, 114688
    s_mov_b32 s67, 917504
    buffer_load_dwordx4 v3, s[48:51], s67 offen lds
    v_add_u32 v9, 49152, v9
    ds_read_b128 v[116:119], v5 offset:49152
    ds_read_b128 v[196:199], v9 offset:16384
    s_waitcnt lgkmcnt(12)
    v_mfma_f32_32x32x16_bf16 v[144:159], v[204:207], v[100:103], v[144:159]
    s_add_u32 m0, s70, 122880
    s_mov_b32 s67, 1146880
    buffer_load_dwordx4 v3, s[48:51], s67 offen lds
    v_add_u32 v10, 49152, v10
    ds_read_b128 v[120:123], v6 offset:49152
    ds_read_b128 v[200:203], v10 offset:16384
    s_waitcnt lgkmcnt(12)
    v_mfma_f32_32x32x16_bf16 v[128:143], v[104:107], v[208:211], v[128:143]
    s_add_u32 m0, s70, 131072
    s_mov_b32 s67, 1376256
    buffer_load_dwordx4 v3, s[48:51], s67 offen lds
    s_add_u32 m0, s70, 147456
    s_lshr_b32 s68, s75, 1
    s_mul_i32 s68, s68, 57344
    buffer_load_dwordx4 v2, s[40:43], s68 offen lds
    v_add_u32 v11, 49152, v11
    ds_read_b128 v[124:127], v7 offset:49152
    ds_read_b128 v[204:207], v11 offset:16384
    s_waitcnt lgkmcnt(12)
    v_mfma_f32_32x32x16_bf16 v[144:159], v[212:215], v[104:107], v[144:159]
    s_add_u32 m0, s70, 139264
    s_mov_b32 s67, 128
    buffer_load_dwordx4 v3, s[44:47], s67 offen lds
    s_mov_b32 s52, s14
    s_mov_b32 s53, s15
    s_mov_b32 s54, 401408
    s_mov_b32 s55, 0x00020000
    s_mov_b32 s40, s16
    s_mov_b32 s41, s17
    s_mov_b32 s42, 401408
    s_mov_b32 s43, 0x00020000
    s_mov_b32 s12, s20
    s_mov_b32 s13, s21
    s_mov_b32 s14, 896
    s_mov_b32 s15, 0x00020000
    s_mul_i32 s73, s3, 57344
    v_add_u32 v12, 49152, v12
    ds_read_b64_tr_b16 v[208:209], v12 offset:24576
    ds_read_b64_tr_b16 v[210:211], v12 offset:25088
    s_waitcnt lgkmcnt(12)
    v_mfma_f32_32x32x16_bf16 v[128:143], v[108:111], v[216:219], v[128:143]
    ds_read_b64_tr_b16 v[212:213], v12 offset:26624
    ds_read_b64_tr_b16 v[214:215], v12 offset:27136
    s_waitcnt lgkmcnt(12)
    v_mfma_f32_32x32x16_bf16 v[144:159], v[220:223], v[108:111], v[144:159]
    ds_read_b64_tr_b16 v[216:217], v12 offset:28672
    ds_read_b64_tr_b16 v[218:219], v12 offset:29184
    s_waitcnt lgkmcnt(12)
    v_mfma_f32_32x32x16_bf16 v[128:143], v[112:115], v[192:195], v[128:143]
    ds_read_b64_tr_b16 v[220:221], v12 offset:30720
    ds_read_b64_tr_b16 v[222:223], v12 offset:31232
    s_waitcnt lgkmcnt(12)
    v_mfma_f32_32x32x16_bf16 v[128:143], v[116:119], v[196:199], v[128:143]
    s_waitcnt vmcnt(6)
    s_barrier
    s_lshl_b32 s68, s22, 11
    v_add_u32 v4, s68, v12
    v_xor_b32 v5, 64, v4
    s_lshl_b32 s68, s22, 5
    v_xor_b32 v6, s68, v8
    v_xor_b32 v7, 4096, v6
    ds_read_b64_tr_b16 v[192:193], v12 offset:32768
    ds_read_b64_tr_b16 v[194:195], v12 offset:33280
    s_waitcnt lgkmcnt(12)
    v_mfma_f32_32x32x16_bf16 v[128:143], v[120:123], v[200:203], v[128:143]
    s_add_u32 m0, s70, 0
    s_mov_b32 s67, 229504
    buffer_load_dwordx4 v3, s[44:47], s67 offen lds
    ds_read_b64_tr_b16 v[196:197], v12 offset:34816
    ds_read_b64_tr_b16 v[198:199], v12 offset:35328
    s_waitcnt lgkmcnt(12)
    v_mfma_f32_32x32x16_bf16 v[128:143], v[124:127], v[204:207], v[128:143]
    ds_read_b64_tr_b16 v[200:201], v12 offset:36864
    ds_read_b64_tr_b16 v[202:203], v12 offset:37376
    s_waitcnt lgkmcnt(12)
    v_mfma_f32_32x32x16_bf16 v[144:159], v[208:211], v[112:115], v[144:159]
    s_add_u32 m0, s70, 8192
    s_mov_b32 s67, 458880
    buffer_load_dwordx4 v3, s[44:47], s67 offen lds
    s_nop 4
    v_permlane16_swap_b32 v128, v136
    v_permlane16_swap_b32 v129, v137
    v_permlane16_swap_b32 v130, v138
    v_permlane16_swap_b32 v131, v139
    v_permlane16_swap_b32 v132, v140
    v_permlane16_swap_b32 v133, v141
    v_permlane16_swap_b32 v134, v142
    v_permlane16_swap_b32 v135, v143
    v_fma_f32 v176, v224, v128, v129
    v_fma_f32 v177, v224, v136, v137
    ds_read_b64_tr_b16 v[204:205], v12 offset:38912
    ds_read_b64_tr_b16 v[206:207], v12 offset:39424
    s_waitcnt lgkmcnt(12)
    v_mfma_f32_32x32x16_bf16 v[144:159], v[212:215], v[116:119], v[144:159]
    v_fma_f32 v176, -v225, v136, v176
    v_fmac_f32 v177, v225, v128
    v_fma_f32 v178, v224, v176, v130
    v_fma_f32 v179, v224, v177, v138
    v_fma_f32 v178, -v225, v177, v178
    v_fmac_f32 v179, v225, v176
    v_fma_f32 v176, v224, v178, v131
    v_fma_f32 v177, v224, v179, v139
    v_fma_f32 v176, -v225, v179, v176
    v_fmac_f32 v177, v225, v178
    ds_read_b64_tr_b16 v[208:209], v12 offset:40960
    ds_read_b64_tr_b16 v[210:211], v12 offset:41472
    s_waitcnt lgkmcnt(12)
    v_mfma_f32_32x32x16_bf16 v[144:159], v[216:219], v[120:123], v[144:159]
    s_add_u32 m0, s70, 16384
    s_mov_b32 s67, 688256
    buffer_load_dwordx4 v3, s[44:47], s67 offen lds
    v_fma_f32 v178, v224, v176, v132
    v_fma_f32 v179, v224, v177, v140
    v_fma_f32 v178, -v225, v177, v178
    v_fmac_f32 v179, v225, v176
    v_fma_f32 v176, v224, v178, v133
    v_fma_f32 v177, v224, v179, v141
    v_fma_f32 v176, -v225, v179, v176
    v_fmac_f32 v177, v225, v178
    v_fma_f32 v178, v224, v176, v134
    v_fma_f32 v179, v224, v177, v142
    ds_read_b64_tr_b16 v[212:213], v12 offset:43008
    ds_read_b64_tr_b16 v[214:215], v12 offset:43520
    s_waitcnt lgkmcnt(12)
    v_mfma_f32_32x32x16_bf16 v[144:159], v[220:223], v[124:127], v[144:159]
    v_fma_f32 v178, -v225, v177, v178
    v_fmac_f32 v179, v225, v176
    v_fma_f32 v176, v224, v178, v135
    v_fma_f32 v177, v224, v179, v143
    v_fma_f32 v176, -v225, v179, v176
    v_fmac_f32 v177, v225, v178
    v_mov_b32 v178, v176
    v_mov_b32 v179, v177
    s_nop 0
    v_permlane32_swap_b32 v176, v178
    v_permlane32_swap_b32 v177, v179
    v_fma_f32 v180, v226, v176, v178
    ds_read_b64_tr_b16 v[216:217], v12 offset:45056
    ds_read_b64_tr_b16 v[218:219], v12 offset:45568
    s_waitcnt lgkmcnt(12)
    v_mfma_f32_32x32x16_bf16 v[160:175], v[192:195], v[16:19], 0
    s_add_u32 m0, s70, 24576
    s_mov_b32 s67, 917632
    buffer_load_dwordx4 v3, s[44:47], s67 offen lds
    v_fma_f32 v181, v226, v177, v179
    v_fma_f32 v180, -v227, v177, v180
    v_fmac_f32 v181, v227, v176
    v_mov_b32 v182, v180
    v_mov_b32 v183, v181
    s_nop 0
    v_permlane16_swap_b32 v180, v182
    v_permlane16_swap_b32 v181, v183
    v_fma_f32 v184, v228, v180, v182
    v_fma_f32 v185, v228, v181, v183
    v_fma_f32 v184, -v229, v181, v184
    v_fmac_f32 v185, v229, v180
    ds_write_b64 v15, v[184:185] offset:384
    ds_read_b64_tr_b16 v[220:221], v12 offset:47104
    ds_read_b64_tr_b16 v[222:223], v12 offset:47616
    s_waitcnt lgkmcnt(13)
    v_mfma_f32_32x32x16_bf16 v[160:175], v[196:199], v[20:23], v[160:175]
    v_cndmask_b32 v178, 0, v180, s[6:7]
    v_cndmask_b32 v179, 0, v181, s[6:7]
    v_fmac_f32 v176, v226, v178
    v_fmac_f32 v177, v226, v179
    ds_read_b64_tr_b16 v[192:193], v12 offset:49152
    ds_read_b64_tr_b16 v[194:195], v12 offset:49664
    s_waitcnt lgkmcnt(13)
    v_mfma_f32_32x32x16_bf16 v[160:175], v[200:203], v[24:27], v[160:175]
    s_add_u32 m0, s70, 32768
    s_mov_b32 s67, 1147008
    buffer_load_dwordx4 v3, s[44:47], s67 offen lds
    v_fma_f32 v176, -v227, v179, v176
    v_fmac_f32 v177, v227, v178
    v_cndmask_b32 v186, v178, v176, s[18:19]
    ds_read_b64_tr_b16 v[196:197], v12 offset:51200
    ds_read_b64_tr_b16 v[198:199], v12 offset:51712
    s_waitcnt lgkmcnt(13)
    v_mfma_f32_32x32x16_bf16 v[160:175], v[204:207], v[28:31], v[160:175]
    v_cndmask_b32 v187, v179, v177, s[18:19]
    v_mul_f32 v8, s101, v144
    v_mul_f32 v9, s101, v145
    v_mul_f32 v10, s101, v146
    v_mul_f32 v11, s101, v147
    ds_read_b64_tr_b16 v[200:201], v12 offset:53248
    ds_read_b64_tr_b16 v[202:203], v12 offset:53760
    s_waitcnt lgkmcnt(13)
    v_mfma_f32_32x32x16_bf16 v[160:175], v[208:211], v[32:35], v[160:175]
    s_add_u32 m0, s70, 40960
    s_mov_b32 s67, 1376384
    buffer_load_dwordx4 v3, s[44:47], s67 offen lds
    v_exp_f32 v8, v8
    v_exp_f32 v9, v9
    ds_read_b64_tr_b16 v[204:205], v12 offset:55296
    ds_read_b64_tr_b16 v[206:207], v12 offset:55808
    s_waitcnt lgkmcnt(13)
    v_mfma_f32_32x32x16_bf16 v[160:175], v[212:215], v[36:39], v[160:175]
    v_exp_f32 v10, v10
    v_exp_f32 v11, v11
    v_add_f32 v8, 1.0, v8
    v_add_f32 v9, 1.0, v9
    s_waitcnt vmcnt(8)
    s_cmp_lg_u32 s64, 5
    s_cbranch_scc1 L_o8
    s_waitcnt vmcnt(15)
    v_readfirstlane_b32 s68, v252
    s_nop 0
    s_cmp_lg_u32 s68, 1
    s_cbranch_scc1 L_gw7
L_gok7:
L_o8:
    s_waitcnt lgkmcnt(0)
    s_barrier
    ds_read_b64_tr_b16 v[208:209], v12 offset:57344
    ds_read_b64_tr_b16 v[210:211], v12 offset:57856
    v_mfma_f32_32x32x16_bf16 v[160:175], v[216:219], v[40:43], v[160:175]
    s_add_u32 m0, s70, 49152
    s_mov_b32 s67, 128
    buffer_load_dwordx4 v3, s[48:51], s67 offen lds
    ds_read_b64 v[176:177], v15 offset:0
    ds_read_b64 v[178:179], v15 offset:128
    ds_read_b64 v[180:181], v15 offset:256
    s_waitcnt lgkmcnt(1)
    v_fmac_f32 v178, v230, v176
    v_fmac_f32 v179, v230, v177
    v_fma_f32 v178, -v231, v177, v178
    v_fmac_f32 v179, v231, v176
    s_waitcnt lgkmcnt(0)
    v_fmac_f32 v180, v230, v178
    v_fmac_f32 v181, v230, v179
    v_fma_f32 v180, -v231, v179, v180
    v_fmac_f32 v181, v231, v178
    ds_read_b64_tr_b16 v[212:213], v12 offset:59392
    ds_read_b64_tr_b16 v[214:215], v12 offset:59904
    v_mfma_f32_32x32x16_bf16 v[160:175], v[220:223], v[44:47], v[160:175]
    s_cmp_lg_u32 s38, 3
    s_cbranch_scc1 L_nopub
    v_fmac_f32 v184, v230, v180
    v_fmac_f32 v185, v230, v181
    v_fma_f32 v184, -v231, v181, v184
    v_fmac_f32 v185, v231, v180
    v_min_u32 v184, 0xfffffffe, v184
    v_min_u32 v185, 0xfffffffe, v185
    v_subrev_u32 v182, 128, v250
    s_mov_b64 exec, 0xffff
    buffer_store_dwordx2 v[184:185], v182, s[60:63], 0 offen sc1
    s_mov_b64 exec, -1
L_nopub:
    v_fmac_f32 v186, v234, v180
    v_fmac_f32 v187, v234, v181
    v_fma_f32 v186, -v235, v181, v186
    ds_read_b64_tr_b16 v[216:217], v12 offset:61440
    ds_read_b64_tr_b16 v[218:219], v12 offset:61952
    v_mfma_f32_32x32x16_bf16 v[160:175], v[192:195], v[48:51], v[160:175]
    s_add_u32 m0, s70, 57344
    s_mov_b32 s67, 229504
    buffer_load_dwordx4 v3, s[48:51], s67 offen lds
    v_fmac_f32 v187, v235, v180
    v_mul_f32 v254, v238, v186
    v_mul_f32 v255, v238, v187
    v_fma_f32 v254, -v239, v187, v254
    v_fmac_f32 v255, v239, v186
    ds_read_b64_tr_b16 v[220:221], v12 offset:63488
    ds_read_b64_tr_b16 v[222:223], v12 offset:64000
    v_mfma_f32_32x32x16_bf16 v[160:175], v[196:199], v[52:55], v[160:175]
    v_add_f32 v10, 1.0, v10
    v_add_f32 v11, 1.0, v11
    v_rcp_f32 v8, v8
    v_rcp_f32 v9, v9
    v_add_u32 v12, 49152, v12
    ds_read_b64_tr_b16 v[192:193], v12 offset:16384
    ds_read_b64_tr_b16 v[194:195], v12 offset:16896
    v_mfma_f32_32x32x16_bf16 v[160:175], v[200:203], v[56:59], v[160:175]
    s_add_u32 m0, s70, 65536
    s_mov_b32 s67, 458880
    buffer_load_dwordx4 v3, s[48:51], s67 offen lds
    v_rcp_f32 v10, v10
    v_rcp_f32 v11, v11
    v_mul_f32 v144, v144, v8
    ds_read_b64_tr_b16 v[196:197], v12 offset:18432
    ds_read_b64_tr_b16 v[198:199], v12 offset:18944
    v_mfma_f32_32x32x16_bf16 v[160:175], v[204:207], v[60:63], v[160:175]
    v_mul_f32 v145, v145, v9
    v_mul_f32 v146, v146, v10
    v_mul_f32 v147, v147, v11
    v_mul_f32 v8, s101, v148
    v_mul_f32 v9, s101, v149
    v_mul_f32 v10, s101, v150
    ds_read_b64_tr_b16 v[200:201], v12 offset:20480
    ds_read_b64_tr_b16 v[202:203], v12 offset:20992
    v_mfma_f32_32x32x16_bf16 v[160:175], v[208:211], v[64:67], v[160:175]
    s_add_u32 m0, s70, 73728
    s_mov_b32 s67, 688256
    buffer_load_dwordx4 v3, s[48:51], s67 offen lds
    v_mul_f32 v11, s101, v151
    v_exp_f32 v8, v8
    v_exp_f32 v9, v9
    ds_read_b64_tr_b16 v[204:205], v12 offset:22528
    ds_read_b64_tr_b16 v[206:207], v12 offset:23040
    s_waitcnt lgkmcnt(12)
    v_mfma_f32_32x32x16_bf16 v[160:175], v[212:215], v[68:71], v[160:175]
    v_exp_f32 v10, v10
    v_exp_f32 v11, v11
    v_add_f32 v8, 1.0, v8
    v_add_f32 v9, 1.0, v9
    ds_read_b64_tr_b16 v[208:209], v12 offset:24576
    ds_read_b64_tr_b16 v[210:211], v12 offset:25088
    s_waitcnt lgkmcnt(12)
    v_mfma_f32_32x32x16_bf16 v[160:175], v[216:219], v[72:75], v[160:175]
    s_add_u32 m0, s70, 81920
    s_mov_b32 s67, 917632
    buffer_load_dwordx4 v3, s[48:51], s67 offen lds
    v_add_f32 v10, 1.0, v10
    v_add_f32 v11, 1.0, v11
    v_rcp_f32 v8, v8
    v_mul_f32 v226, v239, v128
    ds_read_b64_tr_b16 v[212:213], v12 offset:26624
    ds_read_b64_tr_b16 v[214:215], v12 offset:27136
    s_waitcnt lgkmcnt(12)
    v_mfma_f32_32x32x16_bf16 v[160:175], v[220:223], v[76:79], v[160:175]
    v_rcp_f32 v9, v9
    v_rcp_f32 v10, v10
    v_rcp_f32 v11, v11
    ds_read_b64_tr_b16 v[216:217], v12 offset:28672
    ds_read_b64_tr_b16 v[218:219], v12 offset:29184
    s_waitcnt lgkmcnt(12)
    v_mfma_f32_32x32x16_bf16 v[160:175], v[192:195], v[80:83], v[160:175]
    v_mul_f32 v148, v148, v8
    v_mul_f32 v149, v149, v9
    v_mul_f32 v150, v150, v10
    v_mul_f32 v151, v151, v11
    v_mul_f32 v8, s101, v152
    v_mul_f32 v9, s101, v153
    ds_read_b64_tr_b16 v[220:221], v12 offset:30720
    ds_read_b64_tr_b16 v[222:223], v12 offset:31232
    s_waitcnt lgkmcnt(12)
    v_mfma_f32_32x32x16_bf16 v[160:175], v[196:199], v[84:87], v[160:175]
    v_mul_f32 v10, s101, v154
    v_mul_f32 v11, s101, v155
    v_exp_f32 v8, v8
    v_exp_f32 v9, v9
    ds_read_b64_tr_b16 v[192:193], v12 offset:32768
    ds_read_b64_tr_b16 v[194:195], v12 offset:33280
    s_waitcnt lgkmcnt(12)
    v_mfma_f32_32x32x16_bf16 v[160:175], v[200:203], v[88:91], v[160:175]
    v_exp_f32 v10, v10
    v_exp_f32 v11, v11
    v_add_f32 v8, 1.0, v8
    v_add_f32 v9, 1.0, v9
    ds_read_b64_tr_b16 v[196:197], v12 offset:34816
    ds_read_b64_tr_b16 v[198:199], v12 offset:35328
    s_waitcnt lgkmcnt(12)
    v_mfma_f32_32x32x16_bf16 v[160:175], v[204:207], v[92:95], v[160:175]
    v_add_f32 v10, 1.0, v10
    v_add_f32 v11, 1.0, v11
    v_rcp_f32 v8, v8
    v_rcp_f32 v9, v9
    ds_read_b64_tr_b16 v[200:201], v12 offset:36864
    ds_read_b64_tr_b16 v[202:203], v12 offset:37376
    s_waitcnt lgkmcnt(12)
    v_mfma_f32_32x32x16_bf16 v[160:175], v[208:211], v[96:99], v[160:175]
    v_rcp_f32 v10, v10
    v_rcp_f32 v11, v11
    v_mul_f32 v152, v152, v8
    v_mul_f32 v153, v153, v9
    ds_read_b64_tr_b16 v[204:205], v12 offset:38912
    ds_read_b64_tr_b16 v[206:207], v12 offset:39424
    s_waitcnt lgkmcnt(12)
    v_mfma_f32_32x32x16_bf16 v[160:175], v[212:215], v[100:103], v[160:175]
    v_mul_f32 v154, v154, v10
    v_mul_f32 v155, v155, v11
    v_mul_f32 v8, s101, v156
    v_mul_f32 v9, s101, v157
    v_mul_f32 v10, s101, v158
    v_mul_f32 v11, s101, v159
    s_waitcnt vmcnt(8)
    s_barrier
    ds_read_b64_tr_b16 v[208:209], v12 offset:40960
    ds_read_b64_tr_b16 v[210:211], v12 offset:41472
    s_waitcnt lgkmcnt(12)
    v_mfma_f32_32x32x16_bf16 v[160:175], v[216:219], v[104:107], v[160:175]
    s_add_u32 m0, s70, 90112
    s_mov_b32 s67, 1147008
    buffer_load_dwordx4 v3, s[48:51], s67 offen lds
    v_exp_f32 v8, v8
    v_exp_f32 v9, v9
    v_mul_f32 v128, v238, v128
    ds_read_b64_tr_b16 v[212:213], v12 offset:43008
    ds_read_b64_tr_b16 v[214:215], v12 offset:43520
    s_waitcnt lgkmcnt(12)
    v_mfma_f32_32x32x16_bf16 v[160:175], v[220:223], v[108:111], v[160:175]
    v_exp_f32 v10, v10
    v_exp_f32 v11, v11
    v_add_f32 v8, 1.0, v8
    v_add_f32 v9, 1.0, v9
    ds_read_b64_tr_b16 v[216:217], v12 offset:45056
    ds_read_b64_tr_b16 v[218:219], v12 offset:45568
    s_waitcnt lgkmcnt(12)
    v_mfma_f32_32x32x16_bf16 v[160:175], v[192:195], v[112:115], v[160:175]
    s_add_u32 m0, s70, 98304
    s_mov_b32 s67, 1376384
    buffer_load_dwordx4 v3, s[48:51], s67 offen lds
    v_add_f32 v10, 1.0, v10
    v_add_f32 v11, 1.0, v11
    v_rcp_f32 v8, v8
    ds_read_b64_tr_b16 v[220:221], v12 offset:47104
    ds_read_b64_tr_b16 v[222:223], v12 offset:47616
    s_waitcnt lgkmcnt(12)
    v_mfma_f32_32x32x16_bf16 v[160:175], v[196:199], v[116:119], v[160:175]
    v_rcp_f32 v9, v9
    v_rcp_f32 v10, v10
    v_rcp_f32 v11, v11
    v_add_u32 v12, 4294868992, v12
    ds_read_b64_tr_b16 v[192:193], v12 offset:0
    ds_read_b64_tr_b16 v[194:195], v12 offset:512
    s_waitcnt lgkmcnt(12)
    v_mfma_f32_32x32x16_bf16 v[160:175], v[200:203], v[120:123], v[160:175]
    s_add_u32 m0, s70, 106496
    s_mov_b32 s67, 0
    buffer_load_dwordx4 v2, s[92:95], s67 offen lds
    v_mul_f32 v156, v156, v8
    v_mul_f32 v157, v157, v9
    v_mul_f32 v158, v158, v10
    v_mul_f32 v159, v159, v11
    ds_read_b64_tr_b16 v[196:197], v12 offset:2048
    ds_read_b64_tr_b16 v[198:199], v12 offset:2560
    s_waitcnt lgkmcnt(12)
    v_mfma_f32_32x32x16_bf16 v[160:175], v[204:207], v[124:127], v[160:175]
    v_fma_f32 v128, -v239, v136, v128
    v_fma_f32 v136, v238, v136, v226
    v_mul_f32 v227, v239, v129
    v_mul_f32 v129, v238, v129
    ds_read_b64_tr_b16 v[200:201], v12 offset:4096
    ds_read_b64_tr_b16 v[202:203], v12 offset:4608
    s_waitcnt lgkmcnt(12)
    v_mfma_f32_32x32x16_bf16 v[176:191], v[208:211], v[16:19], 0
    s_add_u32 m0, s70, 114688
    s_mov_b32 s67, 802816
    buffer_load_dwordx4 v2, s[92:95], s67 offen lds
    v_fma_f32 v129, -v239, v137, v129
    v_fma_f32 v137, v238, v137, v227
    v_mul_f32 v226, v239, v130
    v_mul_f32 v130, v238, v130
    ds_read_b64_tr_b16 v[204:205], v12 offset:6144
    ds_read_b64_tr_b16 v[206:207], v12 offset:6656
    s_waitcnt lgkmcnt(12)
    v_mfma_f32_32x32x16_bf16 v[176:191], v[212:215], v[20:23], v[176:191]
    v_mul_f32 v160, v160, v144
    v_mul_f32 v161, v161, v145
    v_mul_f32 v162, v162, v146
    v_mul_f32 v163, v163, v147
    v_mul_f32 v164, v164, v148
    v_mul_f32 v165, v165, v149
    v_mul_f32 v166, v166, v150
    v_mul_f32 v167, v167, v151
    v_mul_f32 v168, v168, v152
    v_mul_f32 v169, v169, v153
    v_mul_f32 v170, v170, v154
    v_mul_f32 v171, v171, v155
    ds_read_b64_tr_b16 v[208:209], v12 offset:8192
    ds_read_b64_tr_b16 v[210:211], v12 offset:8704
    s_waitcnt lgkmcnt(12)
    v_mfma_f32_32x32x16_bf16 v[176:191], v[216:219], v[24:27], v[176:191]
    v_mul_f32 v172, v172, v156
    v_mul_f32 v173, v173, v157
    v_mul_f32 v174, v174, v158
    v_mul_f32 v175, v175, v159
    buffer_load_dwordx2 v[152:153], v250, s[60:63], 0 offen offset:0 sc1
    buffer_load_dwordx2 v[154:155], v250, s[60:63], 0 offen offset:128 sc1
    buffer_load_dwordx2 v[156:157], v250, s[60:63], 0 offen offset:256 sc1
    buffer_load_dwordx2 v[158:159], v250, s[60:63], 0 offen offset:384 sc1
    v_cvt_pk_bf16_f32 v144, v160, v161
    v_cvt_pk_bf16_f32 v145, v162, v163
    v_cvt_pk_bf16_f32 v146, v164, v165
    v_cvt_pk_bf16_f32 v147, v166, v167
    s_add_u32 s68, s71, 0
    buffer_store_dwordx4 v[144:147], v13, s[56:59], s68 offen offset:0 sc1
    v_cvt_pk_bf16_f32 v148, v168, v169
    ds_read_b64_tr_b16 v[212:213], v12 offset:10240
    ds_read_b64_tr_b16 v[214:215], v12 offset:10752
    s_waitcnt lgkmcnt(12)
    v_mfma_f32_32x32x16_bf16 v[176:191], v[220:223], v[28:31], v[176:191]
    v_cvt_pk_bf16_f32 v149, v170, v171
    v_cvt_pk_bf16_f32 v150, v172, v173
    v_cvt_pk_bf16_f32 v151, v174, v175
    s_add_u32 s68, s71, 0
    buffer_store_dwordx4 v[148:151], v13, s[56:59], s68 offen offset:1024 sc1
    ds_read_b64_tr_b16 v[216:217], v12 offset:12288
    ds_read_b64_tr_b16 v[218:219], v12 offset:12800
    s_waitcnt lgkmcnt(12)
    v_mfma_f32_32x32x16_bf16 v[176:191], v[192:195], v[32:35], v[176:191]
    v_fma_f32 v130, -v239, v138, v130
    v_fma_f32 v138, v238, v138, v226
    v_mul_f32 v227, v239, v131
    v_mul_f32 v131, v238, v131
    ds_read_b64_tr_b16 v[220:221], v12 offset:14336
    ds_read_b64_tr_b16 v[222:223], v12 offset:14848
    s_waitcnt lgkmcnt(12)
    v_mfma_f32_32x32x16_bf16 v[176:191], v[196:199], v[36:39], v[176:191]
    v_fma_f32 v131, -v239, v139, v131
    v_fma_f32 v139, v238, v139, v227
    v_mul_f32 v226, v239, v132
    v_mul_f32 v132, v238, v132
    ds_read_b64_tr_b16 v[192:193], v12 offset:16384
    ds_read_b64_tr_b16 v[194:195], v12 offset:16896
    s_waitcnt lgkmcnt(12)
    v_mfma_f32_32x32x16_bf16 v[176:191], v[200:203], v[40:43], v[176:191]
    v_fma_f32 v132, -v239, v140, v132
    v_fma_f32 v140, v238, v140, v226
    v_mul_f32 v227, v239, v133
    v_mul_f32 v133, v238, v133
    ds_read_b64_tr_b16 v[196:197], v12 offset:18432
    ds_read_b64_tr_b16 v[198:199], v12 offset:18944
    s_waitcnt lgkmcnt(12)
    v_mfma_f32_32x32x16_bf16 v[176:191], v[204:207], v[44:47], v[176:191]
    v_fma_f32 v133, -v239, v141, v133
    v_fma_f32 v141, v238, v141, v227
    v_mul_f32 v226, v239, v134
    v_mul_f32 v134, v238, v134
    ds_read_b64_tr_b16 v[200:201], v12 offset:20480
    ds_read_b64_tr_b16 v[202:203], v12 offset:20992
    s_waitcnt lgkmcnt(12)
    v_mfma_f32_32x32x16_bf16 v[176:191], v[208:211], v[48:51], v[176:191]
    v_fma_f32 v134, -v239, v142, v134
    v_fma_f32 v142, v238, v142, v226
    v_mul_f32 v227, v239, v135
    v_mul_f32 v135, v238, v135
    ds_read_b64_tr_b16 v[204:205], v12 offset:22528
    ds_read_b64_tr_b16 v[206:207], v12 offset:23040
    s_waitcnt lgkmcnt(12)
    v_mfma_f32_32x32x16_bf16 v[176:191], v[212:215], v[52:55], v[176:191]
    v_fma_f32 v135, -v239, v143, v135
    v_fma_f32 v143, v238, v143, v227
    s_waitcnt vmcnt(15)
    s_barrier
    ds_read_b64_tr_b16 v[208:209], v12 offset:24576
    ds_read_b64_tr_b16 v[210:211], v12 offset:25088
    s_waitcnt lgkmcnt(12)
    v_mfma_f32_32x32x16_bf16 v[176:191], v[216:219], v[56:59], v[176:191]
    s_add_u32 m0, s70, 122880
    s_mov_b32 s67, 114688
    buffer_load_dwordx4 v2, s[92:95], s67 offen lds
    ds_read_b64_tr_b16 v[212:213], v12 offset:26624
    ds_read_b64_tr_b16 v[214:215], v12 offset:27136
    s_waitcnt lgkmcnt(12)
    v_mfma_f32_32x32x16_bf16 v[176:191], v[220:223], v[60:63], v[176:191]
    ds_read_b64_tr_b16 v[216:217], v12 offset:28672
    ds_read_b64_tr_b16 v[218:219], v12 offset:29184
    s_waitcnt lgkmcnt(12)
    v_mfma_f32_32x32x16_bf16 v[176:191], v[192:195], v[64:67], v[176:191]
    s_add_u32 m0, s70, 131072
    s_mov_b32 s67, 917504
    buffer_load_dwordx4 v2, s[92:95], s67 offen lds
L_eck:
    s_waitcnt vmcnt(6)
    v_max3_u32 v144, v152, v153, v154
    s_waitcnt vmcnt(5)
    v_max3_u32 v144, v144, v155, v156
    s_waitcnt vmcnt(4)
    v_max3_u32 v144, v144, v157, v158
    v_max_u32 v144, v144, v159
    v_cmp_eq_u32 vcc, -1, v144
    s_nop 4
    s_cbranch_vccnz L_ew
L_eok:
    ds_read_b64_tr_b16 v[220:221], v12 offset:30720
    ds_read_b64_tr_b16 v[222:223], v12 offset:31232
    s_waitcnt lgkmcnt(12)
    v_mfma_f32_32x32x16_bf16 v[176:191], v[196:199], v[68:71], v[176:191]
    v_fmac_f32 v156, v232, v158
    v_fmac_f32 v157, v232, v159
    v_fma_f32 v156, -v233, v159, v156
    v_fmac_f32 v157, v233, v158
    v_fmac_f32 v154, v232, v156
    ds_read_b64_tr_b16 v[192:193], v12 offset:32768
    ds_read_b64_tr_b16 v[194:195], v12 offset:33280
    s_waitcnt lgkmcnt(12)
    v_mfma_f32_32x32x16_bf16 v[176:191], v[200:203], v[72:75], v[176:191]
    s_add_u32 m0, s70, 139264
    s_mov_b32 s67, 229376
    buffer_load_dwordx4 v2, s[92:95], s67 offen lds
    v_fmac_f32 v155, v232, v157
    v_fma_f32 v154, -v233, v157, v154
    v_fmac_f32 v155, v233, v156
    v_fmac_f32 v152, v232, v154
    v_fmac_f32 v153, v232, v155
    ds_read_b64_tr_b16 v[196:197], v12 offset:34816
    ds_read_b64_tr_b16 v[198:199], v12 offset:35328
    s_waitcnt lgkmcnt(12)
    v_mfma_f32_32x32x16_bf16 v[176:191], v[204:207], v[76:79], v[176:191]
    v_fma_f32 v152, -v233, v155, v152
    v_fmac_f32 v153, v233, v154
    v_mul_f32 v146, v240, v152
    v_mul_f32 v147, v240, v153
    v_fma_f32 v146, -v241, v153, v146
    v_fmac_f32 v147, v241, v152
    ds_read_b64_tr_b16 v[200:201], v12 offset:36864
    ds_read_b64_tr_b16 v[202:203], v12 offset:37376
    s_waitcnt lgkmcnt(12)
    v_mfma_f32_32x32x16_bf16 v[176:191], v[208:211], v[80:83], v[176:191]
    s_add_u32 m0, s70, 0
    s_mov_b32 s67, 1032192
    buffer_load_dwordx4 v2, s[92:95], s67 offen lds
    v_mov_b32 v148, v146
    v_mov_b32 v149, v147
    s_nop 0
    v_permlane16_swap_b32 v146, v148
    v_permlane16_swap_b32 v147, v149
    v_add_f32 v146, v146, v148
    v_add_f32 v147, v147, v149
    v_mov_b32 v148, v146
    ds_read_b64_tr_b16 v[204:205], v12 offset:38912
    ds_read_b64_tr_b16 v[206:207], v12 offset:39424
    s_waitcnt lgkmcnt(12)
    v_mfma_f32_32x32x16_bf16 v[176:191], v[212:215], v[84:87], v[176:191]
    v_mov_b32 v149, v147
    v_permlane32_swap_b32 v146, v148
    s_nop 0
    v_permlane32_swap_b32 v147, v149
    v_add_f32 v146, v146, v148
    v_add_f32 v147, v147, v149
    v_fmac_f32 v254, v236, v146
    ds_read_b64_tr_b16 v[208:209], v12 offset:40960
    ds_read_b64_tr_b16 v[210:211], v12 offset:41472
    s_waitcnt lgkmcnt(12)
    v_mfma_f32_32x32x16_bf16 v[176:191], v[216:219], v[88:91], v[176:191]
    v_fmac_f32 v255, v236, v147
    v_fma_f32 v254, -v237, v147, v254
    v_fmac_f32 v255, v237, v146
    v_fmac_f32 v128, v224, v254
    v_fmac_f32 v136, v224, v255
    ds_read_b64_tr_b16 v[212:213], v12 offset:43008
    ds_read_b64_tr_b16 v[214:215], v12 offset:43520
    s_waitcnt lgkmcnt(12)
    v_mfma_f32_32x32x16_bf16 v[176:191], v[220:223], v[92:95], v[176:191]
    v_fma_f32 v128, -v225, v255, v128
    v_fmac_f32 v136, v225, v254
    v_fmac_f32 v129, v224, v128
    v_fmac_f32 v137, v224, v136
    v_fma_f32 v129, -v225, v136, v129
    ds_read_b64_tr_b16 v[216:217], v12 offset:45056
    ds_read_b64_tr_b16 v[218:219], v12 offset:45568
    s_waitcnt lgkmcnt(12)
    v_mfma_f32_32x32x16_bf16 v[176:191], v[192:195], v[96:99], v[176:191]
    v_fmac_f32 v137, v225, v128
    v_fmac_f32 v130, v224, v129
    v_fmac_f32 v138, v224, v137
    v_fma_f32 v130, -v225, v137, v130
    v_fmac_f32 v138, v225, v129
    ds_read_b64_tr_b16 v[220:221], v12 offset:47104
    ds_read_b64_tr_b16 v[222:223], v12 offset:47616
    s_waitcnt lgkmcnt(12)
    v_mfma_f32_32x32x16_bf16 v[176:191], v[196:199], v[100:103], v[176:191]
    v_fmac_f32 v131, v224, v130
    v_fmac_f32 v139, v224, v138
    v_fma_f32 v131, -v225, v138, v131
    v_fmac_f32 v139, v225, v130
    v_fmac_f32 v132, v224, v131
    s_waitcnt vmcnt(4)
    s_barrier
    s_cmp_lg_u32 s64, 7
    s_cbranch_scc1 L_o9
    v_mov_b32 v252, 2
    s_mov_b64 exec, 1
    buffer_store_dword v252, v251, s[24:27], 0 offen sc1
    s_mov_b64 exec, -1
L_o9:
    ds_read_b64_tr_b16 v[192:193], v12 offset:49152
    ds_read_b64_tr_b16 v[194:195], v12 offset:49664
    s_waitcnt lgkmcnt(12)
    v_mfma_f32_32x32x16_bf16 v[176:191], v[200:203], v[104:107], v[176:191]
    s_add_u32 m0, s70, 8192
    s_mov_b32 s67, 344064
    buffer_load_dwordx4 v2, s[92:95], s67 offen lds
    s_cmp_lg_u32 s64, 5
    s_cbranch_scc1 L_o6
    s_lshr_b32 s68, s75, 1
    s_lshl_b32 s68, s68, 7
    v_mov_b32 v252, s68
    buffer_load_dword v252, v252, s[24:27], 0 offen offset:2052 sc1
L_o6:
    v_fmac_f32 v140, v224, v139
    v_fma_f32 v132, -v225, v139, v132
    v_fmac_f32 v140, v225, v131
    v_fmac_f32 v133, v224, v132
    v_fmac_f32 v141, v224, v140
    ds_read_b64_tr_b16 v[196:197], v12 offset:51200
    ds_read_b64_tr_b16 v[198:199], v12 offset:51712
    s_waitcnt lgkmcnt(12)
    v_mfma_f32_32x32x16_bf16 v[176:191], v[204:207], v[108:111], v[176:191]
    v_fma_f32 v133, -v225, v140, v133
    v_fmac_f32 v141, v225, v132
    v_fmac_f32 v134, v224, v133
    v_fmac_f32 v142, v224, v141
    v_fma_f32 v134, -v225, v141, v134
    ds_read_b64_tr_b16 v[200:201], v12 offset:53248
    ds_read_b64_tr_b16 v[202:203], v12 offset:53760
    s_waitcnt lgkmcnt(12)
    v_mfma_f32_32x32x16_bf16 v[176:191], v[208:211], v[112:115], v[176:191]
    s_add_u32 m0, s70, 16384
    s_mov_b32 s67, 1146880
    buffer_load_dwordx4 v2, s[92:95], s67 offen lds
    v_fmac_f32 v142, v225, v133
    v_fmac_f32 v135, v224, v134
    v_fmac_f32 v143, v224, v142
    v_fma_f32 v135, -v225, v142, v135
    v_fmac_f32 v143, v225, v134
    ds_read_b64_tr_b16 v[204:205], v12 offset:55296
    ds_read_b64_tr_b16 v[206:207], v12 offset:55808
    s_waitcnt lgkmcnt(12)
    v_mfma_f32_32x32x16_bf16 v[176:191], v[212:215], v[116:119], v[176:191]
    v_cvt_pk_bf16_f32 v152, v128, v129
    v_cvt_pk_bf16_f32 v153, v130, v131
    v_cvt_pk_bf16_f32 v154, v132, v133
    v_cvt_pk_bf16_f32 v155, v134, v135
    v_cvt_pk_bf16_f32 v156, -v136, -v137
    v_cvt_pk_bf16_f32 v157, -v138, -v139
    v_cvt_pk_bf16_f32 v158, -v140, -v141
    v_cvt_pk_bf16_f32 v159, -v142, -v143
    ds_read_b64_tr_b16 v[208:209], v12 offset:57344
    ds_read_b64_tr_b16 v[210:211], v12 offset:57856
    s_waitcnt lgkmcnt(12)
    v_mfma_f32_32x32x16_bf16 v[176:191], v[216:219], v[120:123], v[176:191]
    s_add_u32 m0, s70, 24576
    s_mov_b32 s67, 458752
    buffer_load_dwordx4 v2, s[92:95], s67 offen lds
    v_mfma_f32_32x32x16_bf16 v[128:143], v[152:155], v[242:245], 0
    v_mfma_f32_32x32x16_bf16 v[128:143], v[156:159], v[246:249], v[128:143]
    ds_read_b64_tr_b16 v[212:213], v12 offset:59392
    ds_read_b64_tr_b16 v[214:215], v12 offset:59904
    s_waitcnt lgkmcnt(12)
    v_mfma_f32_32x32x16_bf16 v[176:191], v[220:223], v[124:127], v[176:191]
    ds_read_b64_tr_b16 v[216:217], v12 offset:61440
    ds_read_b64_tr_b16 v[218:219], v12 offset:61952
    s_waitcnt lgkmcnt(12)
    v_mfma_f32_32x32x16_bf16 v[160:175], v[192:195], v[16:19], 0
    s_nop 3
    v_cvt_pk_bf16_f32 v152, v128, v129
    v_cvt_pk_bf16_f32 v153, v130, v131
    v_cvt_pk_bf16_f32 v154, v132, v133
    v_cvt_pk_bf16_f32 v155, v134, v135
    v_cvt_pk_bf16_f32 v156, v136, v137
    v_cvt_pk_bf16_f32 v157, v138, v139
    v_cvt_pk_bf16_f32 v158, v140, v141
    v_cvt_pk_bf16_f32 v159, v142, v143
    ds_read_b64_tr_b16 v[220:221], v12 offset:63488
    ds_read_b64_tr_b16 v[222:223], v12 offset:64000
    s_waitcnt lgkmcnt(12)
    v_mfma_f32_32x32x16_bf16 v[160:175], v[196:199], v[20:23], v[160:175]
    buffer_store_dwordx4 v[152:155], v14, s[56:59], s71 offen sc1
    buffer_store_dwordx4 v[156:159], v14, s[56:59], s71 offen offset:256 sc1
    v_add_u32 v12, 49152, v12
    ds_read_b64_tr_b16 v[192:193], v12 offset:16384
    ds_read_b64_tr_b16 v[194:195], v12 offset:16896
    s_waitcnt lgkmcnt(12)
    v_mfma_f32_32x32x16_bf16 v[160:175], v[200:203], v[24:27], v[160:175]
    v_mul_f32 v8, s101, v176
    v_mul_f32 v9, s101, v177
    v_mul_f32 v10, s101, v178
    v_mul_f32 v11, s101, v179
    v_exp_f32 v8, v8
    ds_read_b64_tr_b16 v[196:197], v12 offset:18432
    ds_read_b64_tr_b16 v[198:199], v12 offset:18944
    s_waitcnt lgkmcnt(12)
    v_mfma_f32_32x32x16_bf16 v[160:175], v[204:207], v[28:31], v[160:175]
    v_exp_f32 v9, v9
    v_exp_f32 v10, v10
    v_exp_f32 v11, v11
    ds_read_b64_tr_b16 v[200:201], v12 offset:20480
    ds_read_b64_tr_b16 v[202:203], v12 offset:20992
    s_waitcnt lgkmcnt(12)
    v_mfma_f32_32x32x16_bf16 v[160:175], v[208:211], v[32:35], v[160:175]
    v_add_f32 v8, 1.0, v8
    v_add_f32 v9, 1.0, v9
    v_add_f32 v10, 1.0, v10
    v_add_f32 v11, 1.0, v11
    v_rcp_f32 v8, v8
    ds_read_b64_tr_b16 v[204:205], v12 offset:22528
    ds_read_b64_tr_b16 v[206:207], v12 offset:23040
    s_waitcnt lgkmcnt(12)
    v_mfma_f32_32x32x16_bf16 v[160:175], v[212:215], v[36:39], v[160:175]
    v_rcp_f32 v9, v9
    v_rcp_f32 v10, v10
    v_rcp_f32 v11, v11
    ds_read_b64_tr_b16 v[208:209], v12 offset:24576
    ds_read_b64_tr_b16 v[210:211], v12 offset:25088
    s_waitcnt lgkmcnt(12)
    v_mfma_f32_32x32x16_bf16 v[160:175], v[216:219], v[40:43], v[160:175]
    v_mul_f32 v176, v176, v8
    v_mul_f32 v177, v177, v9
    v_mul_f32 v178, v178, v10
    v_mul_f32 v179, v179, v11
    v_mul_f32 v8, s101, v180
    v_mul_f32 v9, s101, v181
    ds_read_b64_tr_b16 v[212:213], v12 offset:26624
    ds_read_b64_tr_b16 v[214:215], v12 offset:27136
    s_waitcnt lgkmcnt(12)
    v_mfma_f32_32x32x16_bf16 v[160:175], v[220:223], v[44:47], v[160:175]
    v_mul_f32 v10, s101, v182
    v_mul_f32 v11, s101, v183
    v_exp_f32 v8, v8
    v_exp_f32 v9, v9
    ds_read_b64_tr_b16 v[216:217], v12 offset:28672
    ds_read_b64_tr_b16 v[218:219], v12 offset:29184
    s_waitcnt lgkmcnt(12)
    v_mfma_f32_32x32x16_bf16 v[160:175], v[192:195], v[48:51], v[160:175]
    s_cmp_lg_u32 s64, 6
    s_cbranch_scc1 L_o3
    buffer_load_dword v252, v251, s[24:27], 0 offen sc1
L_o3:
    v_exp_f32 v10, v10
    v_exp_f32 v11, v11
    v_add_f32 v8, 1.0, v8
    ds_read_b64_tr_b16 v[220:221], v12 offset:30720
    ds_read_b64_tr_b16 v[222:223], v12 offset:31232
    s_waitcnt lgkmcnt(12)
    v_mfma_f32_32x32x16_bf16 v[160:175], v[196:199], v[52:55], v[160:175]
    v_add_f32 v9, 1.0, v9
    v_add_f32 v10, 1.0, v10
    v_add_f32 v11, 1.0, v11
    v_rcp_f32 v8, v8
    s_barrier
    ds_read_b64_tr_b16 v[192:193], v12 offset:32768
    ds_read_b64_tr_b16 v[194:195], v12 offset:33280
    s_waitcnt lgkmcnt(12)
    v_mfma_f32_32x32x16_bf16 v[160:175], v[200:203], v[56:59], v[160:175]
    s_add_u32 m0, s70, 32768
    s_mov_b32 s67, 1261568
    buffer_load_dwordx4 v2, s[92:95], s67 offen lds
    v_rcp_f32 v9, v9
    v_rcp_f32 v10, v10
    ds_read_b64_tr_b16 v[196:197], v12 offset:34816
    ds_read_b64_tr_b16 v[198:199], v12 offset:35328
    s_waitcnt lgkmcnt(12)
    v_mfma_f32_32x32x16_bf16 v[160:175], v[204:207], v[60:63], v[160:175]
    v_rcp_f32 v11, v11
    v_mul_f32 v180, v180, v8
    v_mul_f32 v181, v181, v9
    v_mul_f32 v182, v182, v10
    v_mul_f32 v183, v183, v11
    ds_read_b64_tr_b16 v[200:201], v12 offset:36864
    ds_read_b64_tr_b16 v[202:203], v12 offset:37376
    s_waitcnt lgkmcnt(12)
    v_mfma_f32_32x32x16_bf16 v[160:175], v[208:211], v[64:67], v[160:175]
    s_add_u32 m0, s70, 40960
    s_mov_b32 s67, 573440
    buffer_load_dwordx4 v2, s[92:95], s67 offen lds
    v_mul_f32 v8, s101, v184
    v_mul_f32 v9, s101, v185
    v_mul_f32 v10, s101, v186
    v_mul_f32 v11, s101, v187
    ds_read_b64_tr_b16 v[204:205], v12 offset:38912
    ds_read_b64_tr_b16 v[206:207], v12 offset:39424
    s_waitcnt lgkmcnt(12)
    v_mfma_f32_32x32x16_bf16 v[160:175], v[212:215], v[68:71], v[160:175]
    v_exp_f32 v8, v8
    v_exp_f32 v9, v9
    v_exp_f32 v10, v10
    ds_read_b64_tr_b16 v[208:209], v12 offset:40960
    ds_read_b64_tr_b16 v[210:211], v12 offset:41472
    s_waitcnt lgkmcnt(12)
    v_mfma_f32_32x32x16_bf16 v[160:175], v[216:219], v[72:75], v[160:175]
    s_add_u32 m0, s70, 49152
    s_mov_b32 s67, 1376256
    buffer_load_dwordx4 v2, s[92:95], s67 offen lds
    v_exp_f32 v11, v11
    v_add_f32 v8, 1.0, v8
    v_add_f32 v9, 1.0, v9
    v_add_f32 v10, 1.0, v10
    ds_read_b64_tr_b16 v[212:213], v12 offset:43008
    ds_read_b64_tr_b16 v[214:215], v12 offset:43520
    s_waitcnt lgkmcnt(12)
    v_mfma_f32_32x32x16_bf16 v[160:175], v[220:223], v[76:79], v[160:175]
    v_add_f32 v11, 1.0, v11
    v_rcp_f32 v8, v8
    v_rcp_f32 v9, v9
    ds_read_b64_tr_b16 v[216:217], v12 offset:45056
    ds_read_b64_tr_b16 v[218:219], v12 offset:45568
    s_waitcnt lgkmcnt(12)
    v_mfma_f32_32x32x16_bf16 v[160:175], v[192:195], v[80:83], v[160:175]
    s_add_u32 m0, s70, 57344
    s_mov_b32 s67, 688128
    buffer_load_dwordx4 v2, s[92:95], s67 offen lds
    v_rcp_f32 v10, v10
    v_rcp_f32 v11, v11
    v_mul_f32 v184, v184, v8
    ds_read_b64_tr_b16 v[220:221], v12 offset:47104
    ds_read_b64_tr_b16 v[222:223], v12 offset:47616
    s_waitcnt lgkmcnt(12)
    v_mfma_f32_32x32x16_bf16 v[160:175], v[196:199], v[84:87], v[160:175]
    v_mul_f32 v185, v185, v9
    v_mul_f32 v186, v186, v10
    v_mul_f32 v187, v187, v11
    v_mul_f32 v8, s101, v188
    v_mul_f32 v9, s101, v189
    v_mul_f32 v10, s101, v190
    ds_read_b64_tr_b16 v[192:193], v12 offset:49152
    ds_read_b64_tr_b16 v[194:195], v12 offset:49664
    s_waitcnt lgkmcnt(12)
    v_mfma_f32_32x32x16_bf16 v[160:175], v[200:203], v[88:91], v[160:175]
    v_mul_f32 v11, s101, v191
    v_exp_f32 v8, v8
    v_exp_f32 v9, v9
    ds_read_b64_tr_b16 v[196:197], v12 offset:51200
    ds_read_b64_tr_b16 v[198:199], v12 offset:51712
    s_waitcnt lgkmcnt(12)
    v_mfma_f32_32x32x16_bf16 v[160:175], v[204:207], v[92:95], v[160:175]
    v_exp_f32 v10, v10
    v_exp_f32 v11, v11
    v_add_f32 v8, 1.0, v8
    v_add_f32 v9, 1.0, v9
    ds_read_b64_tr_b16 v[200:201], v12 offset:53248
    ds_read_b64_tr_b16 v[202:203], v12 offset:53760
    s_waitcnt lgkmcnt(12)
    v_mfma_f32_32x32x16_bf16 v[160:175], v[208:211], v[96:99], v[160:175]
    v_add_f32 v10, 1.0, v10
    v_add_f32 v11, 1.0, v11
    v_rcp_f32 v8, v8
    v_rcp_f32 v9, v9
    ds_read_b64_tr_b16 v[204:205], v12 offset:55296
    ds_read_b64_tr_b16 v[206:207], v12 offset:55808
    s_waitcnt lgkmcnt(12)
    v_mfma_f32_32x32x16_bf16 v[160:175], v[212:215], v[100:103], v[160:175]
    v_rcp_f32 v10, v10
    v_rcp_f32 v11, v11
    v_mul_f32 v188, v188, v8
    v_mul_f32 v189, v189, v9
    s_waitcnt vmcnt(12)
    s_cmp_lg_u32 s64, 6
    s_cbranch_scc1 L_fok12
    s_waitcnt vmcnt(4)
    v_cmp_lt_u32 vcc, 2, v252
    s_nop 4
    s_cbranch_vccnz L_fw12
L_fok12:
    s_barrier
    ds_read_b64_tr_b16 v[208:209], v5 offset:57344
    ds_read_b64_tr_b16 v[210:211], v5 offset:57856
    s_waitcnt lgkmcnt(12)
    v_mfma_f32_32x32x16_bf16 v[160:175], v[216:219], v[104:107], v[160:175]
    s_mov_b32 s69, 0
    buffer_load_dwordx4 v[16:19], v253, s[56:59], s69 offen sc1
    s_mov_b32 s69, 57344
    buffer_load_dwordx4 v[20:23], v253, s[56:59], s69 offen sc1
    v_mul_f32 v190, v190, v10
    v_mul_f32 v191, v191, v11
    ds_read_b64_tr_b16 v[212:213], v4 offset:57344
    ds_read_b64_tr_b16 v[214:215], v4 offset:57856
    s_waitcnt lgkmcnt(12)
    v_mfma_f32_32x32x16_bf16 v[160:175], v[220:223], v[108:111], v[160:175]
    s_mov_b32 s69, 8192
    buffer_load_dwordx4 v[24:27], v253, s[56:59], s69 offen sc1
    s_mov_b32 s69, 65536
    buffer_load_dwordx4 v[28:31], v253, s[56:59], s69 offen sc1
    v_add_u32 v5, 49152, v5
    ds_read_b64_tr_b16 v[216:217], v5 offset:16384
    ds_read_b64_tr_b16 v[218:219], v5 offset:16896
    s_waitcnt lgkmcnt(12)
    v_mfma_f32_32x32x16_bf16 v[160:175], v[192:195], v[112:115], v[160:175]
    s_mov_b32 s69, 16384
    buffer_load_dwordx4 v[32:35], v253, s[56:59], s69 offen sc1
    s_mov_b32 s69, 73728
    buffer_load_dwordx4 v[36:39], v253, s[56:59], s69 offen sc1
    v_add_u32 v4, 49152, v4
    ds_read_b64_tr_b16 v[220:221], v4 offset:16384
    ds_read_b64_tr_b16 v[222:223], v4 offset:16896
    s_waitcnt lgkmcnt(12)
    v_mfma_f32_32x32x16_bf16 v[160:175], v[196:199], v[116:119], v[160:175]
    s_mov_b32 s69, 24576
    buffer_load_dwordx4 v[40:43], v253, s[56:59], s69 offen sc1
    s_mov_b32 s69, 81920
    buffer_load_dwordx4 v[44:47], v253, s[56:59], s69 offen sc1
    ds_read_b64_tr_b16 v[192:193], v5 offset:24576
    ds_read_b64_tr_b16 v[194:195], v5 offset:25088
    s_waitcnt lgkmcnt(12)
    v_mfma_f32_32x32x16_bf16 v[160:175], v[200:203], v[120:123], v[160:175]
    s_mov_b32 s69, 32768
    buffer_load_dwordx4 v[48:51], v253, s[56:59], s69 offen sc1
    s_mov_b32 s69, 90112
    buffer_load_dwordx4 v[52:55], v253, s[56:59], s69 offen sc1
    ds_read_b64_tr_b16 v[196:197], v4 offset:24576
    ds_read_b64_tr_b16 v[198:199], v4 offset:25088
    s_waitcnt lgkmcnt(12)
    v_mfma_f32_32x32x16_bf16 v[160:175], v[204:207], v[124:127], v[160:175]
    s_mov_b32 s69, 40960
    buffer_load_dwordx4 v[56:59], v253, s[56:59], s69 offen sc1
    s_mov_b32 s69, 98304
    buffer_load_dwordx4 v[60:63], v253, s[56:59], s69 offen sc1
    s_waitcnt vmcnt(21)
    s_waitcnt vmcnt(16)
    s_cmp_lg_u32 s64, 5
    s_cbranch_scc1 L_o16
    s_waitcnt vmcnt(20)
    v_readfirstlane_b32 s68, v252
    s_nop 0
    s_cmp_lg_u32 s68, 1
    s_cbranch_scc1 L_gw15
L_gok15:
    s_add_u32 s44, s36, 11010048
    s_addc_u32 s45, s37, 0
    s_mov_b32 s46, 16384
    s_mov_b32 s47, 0x00020000
    s_mov_b32 m0, 157696
    v_lshlrev_b32 v252, 2, v0
    s_lshr_b32 s68, s75, 1
    s_lshl_b32 s68, s68, 8
    buffer_load_dword v252, s[44:47], s68 offen sc1 lds
    s_mov_b32 m0, 157952
    s_add_u32 s68, s68, 8192
    buffer_load_dword v252, s[44:47], s68 offen sc1 lds
L_o16:
    s_barrier
    s_cmp_lg_u32 s64, 7
    s_cbranch_scc1 L_o10
    v_mov_b32 v252, 1
    s_mov_b64 exec, 1
    buffer_store_dword v252, v251, s[24:27], 0 offen sc1
    s_mov_b64 exec, -1
L_o10:
    ds_read_b64_tr_b16 v[200:201], v5 offset:32768
    ds_read_b64_tr_b16 v[202:203], v5 offset:33280
    s_waitcnt vmcnt(11) lgkmcnt(12)
    v_mfma_f32_32x32x16_bf16 v[144:159], v[16:19], v[208:211], 0
    s_mov_b32 s69, 49152
    buffer_load_dwordx4 v[64:67], v253, s[56:59], s69 offen sc1
    s_mov_b32 s69, 106496
    buffer_load_dwordx4 v[68:71], v253, s[56:59], s69 offen sc1
    ds_read_b64_tr_b16 v[204:205], v4 offset:32768
    ds_read_b64_tr_b16 v[206:207], v4 offset:33280
    s_waitcnt lgkmcnt(12)
    v_mfma_f32_32x32x16_bf16 v[128:143], v[16:19], v[212:215], 0
    v_mul_f32 v160, v160, v176
    v_mul_f32 v161, v161, v177
    v_mul_f32 v162, v162, v178
    v_mul_f32 v163, v163, v179
    v_mul_f32 v164, v164, v180
    v_mul_f32 v165, v165, v181
    ds_read_b64_tr_b16 v[208:209], v5 offset:40960
    ds_read_b64_tr_b16 v[210:211], v5 offset:41472
    s_waitcnt vmcnt(12) lgkmcnt(12)
    v_mfma_f32_32x32x16_bf16 v[144:159], v[20:23], v[216:219], v[144:159]
    v_mul_f32 v166, v166, v182
    v_mul_f32 v167, v167, v183
    v_mul_f32 v168, v168, v184
    v_mul_f32 v169, v169, v185
    v_mul_f32 v170, v170, v186
    v_mul_f32 v171, v171, v187
    ds_read_b64_tr_b16 v[212:213], v4 offset:40960
    ds_read_b64_tr_b16 v[214:215], v4 offset:41472
    s_waitcnt lgkmcnt(12)
    v_mfma_f32_32x32x16_bf16 v[128:143], v[20:23], v[220:223], v[128:143]
    v_mul_f32 v172, v172, v188
    v_mul_f32 v173, v173, v189
    v_mul_f32 v174, v174, v190
    v_mul_f32 v175, v175, v191
    v_cvt_pk_bf16_f32 v176, v160, v161
    v_cvt_pk_bf16_f32 v177, v162, v163
    v_add_u32 v5, 4294868992, v5
    ds_read_b64_tr_b16 v[216:217], v5 offset:0
    ds_read_b64_tr_b16 v[218:219], v5 offset:512
    s_waitcnt vmcnt(11) lgkmcnt(12)
    v_mfma_f32_32x32x16_bf16 v[144:159], v[24:27], v[192:195], v[144:159]
    v_cvt_pk_bf16_f32 v178, v164, v165
    v_cvt_pk_bf16_f32 v179, v166, v167
    s_add_u32 s68, s71, 4096
    buffer_store_dwordx4 v[176:179], v13, s[56:59], s68 offen offset:0 sc1
    v_cvt_pk_bf16_f32 v180, v168, v169
    v_cvt_pk_bf16_f32 v181, v170, v171
    v_cvt_pk_bf16_f32 v182, v172, v173
    v_add_u32 v4, 4294868992, v4
    ds_read_b64_tr_b16 v[220:221], v4 offset:0
    ds_read_b64_tr_b16 v[222:223], v4 offset:512
    s_waitcnt lgkmcnt(12)
    v_mfma_f32_32x32x16_bf16 v[128:143], v[24:27], v[196:199], v[128:143]
    v_cvt_pk_bf16_f32 v183, v174, v175
    s_add_u32 s68, s71, 4096
    buffer_store_dwordx4 v[180:183], v13, s[56:59], s68 offen offset:1024 sc1
    s_barrier
    ds_read_b64_tr_b16 v[192:193], v5 offset:8192
    ds_read_b64_tr_b16 v[194:195], v5 offset:8704
    s_waitcnt vmcnt(12) lgkmcnt(12)
    v_mfma_f32_32x32x16_bf16 v[144:159], v[28:31], v[200:203], v[144:159]
    ds_read_b64_tr_b16 v[196:197], v4 offset:8192
    ds_read_b64_tr_b16 v[198:199], v4 offset:8704
    s_waitcnt lgkmcnt(12)
    v_mfma_f32_32x32x16_bf16 v[128:143], v[28:31], v[204:207], v[128:143]
    ds_read_b64_tr_b16 v[200:201], v5 offset:16384
    ds_read_b64_tr_b16 v[202:203], v5 offset:16896
    s_waitcnt vmcnt(11) lgkmcnt(12)
    v_mfma_f32_32x32x16_bf16 v[144:159], v[32:35], v[208:211], v[144:159]
    s_add_u32 m0, s70, 65536
    s_mov_b32 s67, 1490944
    buffer_load_dwordx4 v2, s[92:95], s67 offen lds
    ds_read_b64_tr_b16 v[204:205], v4 offset:16384
    ds_read_b64_tr_b16 v[206:207], v4 offset:16896
    s_waitcnt lgkmcnt(12)
    v_mfma_f32_32x32x16_bf16 v[128:143], v[32:35], v[212:215], v[128:143]
    ds_read_b64_tr_b16 v[208:209], v5 offset:24576
    ds_read_b64_tr_b16 v[210:211], v5 offset:25088
    s_waitcnt vmcnt(11) lgkmcnt(12)
    v_mfma_f32_32x32x16_bf16 v[144:159], v[36:39], v[216:219], v[144:159]
    s_add_u32 m0, s70, 73728
    s_add_u32 s67, s73, 0
    buffer_load_dwordx4 v1, s[52:55], s67 offen lds
    s_cmp_lg_u32 s64, 6
    s_cbranch_scc1 L_o4
    buffer_load_dword v252, v251, s[24:27], 0 offen sc1
L_o4:
    ds_read_b64_tr_b16 v[212:213], v4 offset:24576
    ds_read_b64_tr_b16 v[214:215], v4 offset:25088
    s_waitcnt lgkmcnt(12)
    v_mfma_f32_32x32x16_bf16 v[128:143], v[36:39], v[220:223], v[128:143]
    s_barrier
    ds_read_b64_tr_b16 v[216:217], v5 offset:32768
    ds_read_b64_tr_b16 v[218:219], v5 offset:33280
    s_waitcnt vmcnt(11) lgkmcnt(12)
    v_mfma_f32_32x32x16_bf16 v[144:159], v[40:43], v[192:195], v[144:159]
    s_add_u32 m0, s70, 81920
    s_add_u32 s67, s73, 0
    buffer_load_dwordx4 v1, s[40:43], s67 offen lds
    ds_read_b64_tr_b16 v[220:221], v4 offset:32768
    ds_read_b64_tr_b16 v[222:223], v4 offset:33280
    s_waitcnt lgkmcnt(12)
    v_mfma_f32_32x32x16_bf16 v[128:143], v[40:43], v[196:199], v[128:143]
    ds_read_b64_tr_b16 v[192:193], v5 offset:40960
    ds_read_b64_tr_b16 v[194:195], v5 offset:41472
    s_waitcnt vmcnt(11) lgkmcnt(12)
    v_mfma_f32_32x32x16_bf16 v[144:159], v[44:47], v[200:203], v[144:159]
    s_add_u32 m0, s70, 90112
    s_add_u32 s67, s73, 128
    buffer_load_dwordx4 v1, s[52:55], s67 offen lds
    ds_read_b64_tr_b16 v[196:197], v4 offset:40960
    ds_read_b64_tr_b16 v[198:199], v4 offset:41472
    s_waitcnt lgkmcnt(12)
    v_mfma_f32_32x32x16_bf16 v[128:143], v[44:47], v[204:207], v[128:143]
    ds_read_b64_tr_b16 v[200:201], v5 offset:49152
    ds_read_b64_tr_b16 v[202:203], v5 offset:49664
    s_waitcnt vmcnt(11) lgkmcnt(12)
    v_mfma_f32_32x32x16_bf16 v[144:159], v[48:51], v[208:211], v[144:159]
    s_add_u32 m0, s70, 98304
    s_add_u32 s67, s73, 128
    buffer_load_dwordx4 v1, s[40:43], s67 offen lds
    ds_read_b64_tr_b16 v[204:205], v4 offset:49152
    ds_read_b64_tr_b16 v[206:207], v4 offset:49664
    s_waitcnt lgkmcnt(12)
    v_mfma_f32_32x32x16_bf16 v[128:143], v[48:51], v[212:215], v[128:143]
    s_waitcnt vmcnt(3)
    s_cmp_lg_u32 s64, 6
    s_cbranch_scc1 L_fok13
    s_waitcnt vmcnt(3)
    v_cmp_lt_u32 vcc, 1, v252
    s_nop 4
    s_cbranch_vccnz L_fw13
L_fok13:
    s_cmp_lg_u32 s64, 5
    s_cbranch_scc1 L_o17
    s_waitcnt vmcnt(9)
L_o17:
    s_barrier
    ds_read_b64_tr_b16 v[208:209], v5 offset:57344
    ds_read_b64_tr_b16 v[210:211], v5 offset:57856
    s_waitcnt lgkmcnt(12)
    v_mfma_f32_32x32x16_bf16 v[144:159], v[52:55], v[216:219], v[144:159]
    s_mov_b32 s69, 114688
    buffer_load_dwordx4 v[72:75], v253, s[56:59], s69 offen sc1
    s_add_u32 m0, s70, 106496
    s_add_u32 s67, s73, 256
    buffer_load_dwordx4 v1, s[52:55], s67 offen lds
    ds_read_b64_tr_b16 v[212:213], v4 offset:57344
    ds_read_b64_tr_b16 v[214:215], v4 offset:57856
    s_waitcnt lgkmcnt(12)
    v_mfma_f32_32x32x16_bf16 v[128:143], v[52:55], v[220:223], v[128:143]
    v_add_u32 v5, 49152, v5
    ds_read_b64_tr_b16 v[216:217], v5 offset:16384
    ds_read_b64_tr_b16 v[218:219], v5 offset:16896
    s_waitcnt lgkmcnt(12)
    v_mfma_f32_32x32x16_bf16 v[144:159], v[56:59], v[192:195], v[144:159]
    s_mov_b32 s69, 143360
    buffer_load_dwordx4 v[76:79], v253, s[56:59], s69 offen sc1
    s_add_u32 m0, s70, 114688
    s_add_u32 s67, s73, 256
    buffer_load_dwordx4 v1, s[40:43], s67 offen lds
    v_add_u32 v4, 49152, v4
    ds_read_b64_tr_b16 v[220:221], v4 offset:16384
    ds_read_b64_tr_b16 v[222:223], v4 offset:16896
    s_waitcnt lgkmcnt(12)
    v_mfma_f32_32x32x16_bf16 v[128:143], v[56:59], v[196:199], v[128:143]
    ds_read_b128 v[192:195], v7 offset:24576
    s_waitcnt lgkmcnt(11)
    v_mfma_f32_32x32x16_bf16 v[144:159], v[60:63], v[200:203], v[144:159]
    s_mov_b32 s69, 118784
    buffer_load_dwordx4 v[80:83], v253, s[56:59], s69 offen sc1
    s_add_u32 m0, s70, 122880
    s_add_u32 s67, s73, 384
    buffer_load_dwordx4 v1, s[52:55], s67 offen lds
    ds_read_b128 v[196:199], v6 offset:24576
    s_waitcnt lgkmcnt(10)
    v_mfma_f32_32x32x16_bf16 v[128:143], v[60:63], v[204:207], v[128:143]
    s_waitcnt vmcnt(6)
    s_barrier
    ds_read_b128 v[200:203], v7 offset:32768
    s_waitcnt lgkmcnt(9)
    v_mfma_f32_32x32x16_bf16 v[144:159], v[64:67], v[208:211], v[144:159]
    s_mov_b32 s69, 147456
    buffer_load_dwordx4 v[84:87], v253, s[56:59], s69 offen sc1
    s_add_u32 m0, s70, 131072
    s_add_u32 s67, s73, 384
    buffer_load_dwordx4 v1, s[40:43], s67 offen lds
    s_mov_b32 s48, s32
    s_mov_b32 s49, s33
    s_mov_b32 s50, 3670016
    s_mov_b32 s51, 0x00020000
    v_and_b32 v249, 31, v0
    v_lshrrev_b32 v250, 1, v249
    v_xor_b32 v250, v250, v249
    ds_read_b128 v[204:207], v6 offset:32768
    s_waitcnt lgkmcnt(8)
    v_mfma_f32_32x32x16_bf16 v[128:143], v[64:67], v[212:215], v[128:143]
    v_and_b32 v250, 4, v250
    v_mul_u32_u24 v250, 3, v250
    v_xor_b32 v249, v250, v249
    v_lshrrev_b32 v250, 5, v0
    ds_read_b128 v[208:211], v7 offset:40960
    s_waitcnt lgkmcnt(7)
    v_mfma_f32_32x32x16_bf16 v[144:159], v[68:71], v[216:219], v[144:159]
    s_mov_b32 s69, 122880
    buffer_load_dwordx4 v[88:91], v253, s[56:59], s69 offen sc1
    s_add_u32 m0, s70, 139264
    s_add_u32 s67, s73, 512
    buffer_load_dwordx4 v1, s[52:55], s67 offen lds
    s_lshl_b32 s68, s3, 1
    s_add_u32 s68, s68, s39
    s_lshl_b32 s68, s68, 5
    v_add_u32 v3, s68, v249
    v_lshlrev_b32 v3, 1, v3
    buffer_load_ushort v248, v3, s[12:15], 0 offen
    ds_read_b128 v[212:215], v6 offset:40960
    s_waitcnt lgkmcnt(6)
    v_mfma_f32_32x32x16_bf16 v[128:143], v[68:71], v[220:223], v[128:143]
    s_lshl_b32 s68, s75, 1
    s_and_b32 s69, s22, 1
    s_add_u32 s68, s68, s69
    s_lshl_b32 s68, s68, 4
    v_lshl_add_u32 v250, v250, 2, s68
    v_mul_u32_u24 v14, 896, v250
    v_add_u32 v14, v14, v3
    v_lshlrev_b32 v14, 1, v14
    ds_read_b128 v[216:219], v7 offset:49152
    s_waitcnt vmcnt(10) lgkmcnt(6)
    v_mfma_f32_32x32x16_bf16 v[176:191], v[72:75], v[192:195], 0
    s_mov_b32 s69, 151552
    buffer_load_dwordx4 v[92:95], v253, s[56:59], s69 offen sc1
    s_add_u32 m0, s70, 0
    s_add_u32 s67, s73, 512
    buffer_load_dwordx4 v1, s[40:43], s67 offen lds
    v_and_b32 v250, 63, v250
    v_lshlrev_b32 v13, 2, v250
    v_add_u32 v13, 157696, v13
    v_lshlrev_b32 v12, 7, v250
    ds_read_b128 v[220:223], v6 offset:49152
    s_waitcnt lgkmcnt(6)
    v_mfma_f32_32x32x16_bf16 v[160:175], v[72:75], v[196:199], 0
    v_lshl_add_u32 v12, v249, 1, v12
    s_lshl_b32 s68, s39, 6
    s_add_u32 s68, s68, 147456
    v_add_u32 v12, s68, v12
    v_xor_b32 v254, 64, v12
    v_lshlrev_b32 v249, 4, v0
    s_waitcnt vmcnt(7)
    s_barrier
    s_cmp_lg_u32 s64, 7
    s_cbranch_scc1 L_o11
    v_mov_b32 v252, 0
    s_mov_b64 exec, 1
    buffer_store_dword v252, v251, s[24:27], 0 offen sc1
    s_mov_b64 exec, -1
L_o11:
    ds_read_b128 v[192:195], v7 offset:57344
    s_waitcnt lgkmcnt(6)
    v_mfma_f32_32x32x16_bf16 v[176:191], v[76:79], v[200:203], v[176:191]
    s_mov_b32 s69, 126976
    buffer_load_dwordx4 v[96:99], v253, s[56:59], s69 offen sc1
    s_add_u32 m0, s70, 8192
    s_add_u32 s67, s73, 640
    buffer_load_dwordx4 v1, s[52:55], s67 offen lds
    s_mul_i32 s68, s64, 6144
    s_add_u32 s68, s68, 8192
    v_add_u32 v15, s68, v249
    s_xor_b32 s68, s64, 2
    s_mul_i32 s68, s68, 6144
    s_add_u32 s68, s68, 8192
    v_add_u32 v8, s68, v249
    s_xor_b32 s68, s64, 4
    s_mul_i32 s68, s68, 6144
    s_add_u32 s68, s68, 10240
    v_add_u32 v9, s68, v249
    ds_read_b128 v[196:199], v6 offset:57344
    s_waitcnt lgkmcnt(6)
    v_mfma_f32_32x32x16_bf16 v[160:175], v[76:79], v[204:207], v[160:175]
    s_xor_b32 s68, s64, 6
    s_mul_i32 s68, s68, 6144
    s_add_u32 s68, s68, 12288
    v_add_u32 v10, s68, v249
    ds_read_u16 v224, v12 offset:0
    ds_read_u16 v225, v12 offset:128
    ds_read_u16 v226, v254 offset:256
    ds_read_u16 v227, v254 offset:384
    ds_read_u16 v228, v12 offset:1024
    ds_read_u16 v229, v12 offset:1152
    ds_read_u16 v230, v254 offset:1280
    ds_read_u16 v231, v254 offset:1408
    ds_read_b128 v[232:235], v13 offset:0
    v_add_u32 v7, 49152, v7
    ds_read_b128 v[200:203], v7 offset:16384
    s_waitcnt lgkmcnt(15)
    v_mfma_f32_32x32x16_bf16 v[176:191], v[80:83], v[208:211], v[176:191]
    s_mov_b32 s69, 155648
    buffer_load_dwordx4 v[100:103], v253, s[56:59], s69 offen sc1
    s_add_u32 m0, s70, 16384
    s_add_u32 s67, s73, 640
    buffer_load_dwordx4 v1, s[40:43], s67 offen lds
    ds_read_b128 v[240:243], v13 offset:256
    ds_read_b128 v[236:239], v13 offset:32
    ds_read_b128 v[244:247], v13 offset:288
    s_waitcnt vmcnt(6)
    v_lshlrev_b32 v248, 16, v248
    s_waitcnt lgkmcnt(12)
    v_lshlrev_b32 v224, 16, v224
    v_mul_f32 v224, v224, v248
    v_add_u32 v6, 49152, v6
    ds_read_b128 v[204:207], v6 offset:16384
    v_mfma_f32_32x32x16_bf16 v[160:175], v[80:83], v[212:215], v[160:175]
    s_waitcnt lgkmcnt(12)
    v_lshlrev_b32 v225, 16, v225
    v_mul_f32 v225, v225, v248
    s_waitcnt lgkmcnt(11)
    v_lshlrev_b32 v226, 16, v226
    v_mul_f32 v226, v226, v248
    s_waitcnt lgkmcnt(10)
    v_lshlrev_b32 v227, 16, v227
    v_mul_f32 v227, v227, v248
    ds_read_b128 v[208:211], v7 offset:24576
    v_mfma_f32_32x32x16_bf16 v[176:191], v[84:87], v[216:219], v[176:191]
    s_mov_b32 s69, 131072
    buffer_load_dwordx4 v[104:107], v253, s[56:59], s69 offen sc1
    s_add_u32 m0, s70, 24576
    s_add_u32 s67, s73, 768
    buffer_load_dwordx4 v1, s[52:55], s67 offen lds
    s_waitcnt lgkmcnt(10)
    v_lshlrev_b32 v228, 16, v228
    v_mul_f32 v228, v228, v248
    s_waitcnt lgkmcnt(9)
    v_lshlrev_b32 v229, 16, v229
    v_mul_f32 v229, v229, v248
    ds_read_b128 v[212:215], v6 offset:24576
    v_mfma_f32_32x32x16_bf16 v[160:175], v[84:87], v[220:223], v[160:175]
    s_waitcnt lgkmcnt(9)
    v_lshlrev_b32 v230, 16, v230
    v_mul_f32 v230, v230, v248
    s_waitcnt lgkmcnt(8)
    v_lshlrev_b32 v231, 16, v231
    v_mul_f32 v231, v231, v248
    v_cvt_pk_bf16_f32 v225, v224, v225
    v_lshlrev_b32 v224, 16, v225
    s_waitcnt vmcnt(6)
    s_barrier
    ds_read_b128 v[216:219], v7 offset:32768
    v_mfma_f32_32x32x16_bf16 v[176:191], v[88:91], v[192:195], v[176:191]
    s_mov_b32 s69, 159744
    buffer_load_dwordx4 v[108:111], v253, s[56:59], s69 offen sc1
    s_add_u32 m0, s70, 32768
    s_add_u32 s67, s73, 768
    buffer_load_dwordx4 v1, s[40:43], s67 offen lds
    s_cmp_lg_u32 s64, 6
    s_cbranch_scc1 L_o5
    buffer_load_dword v252, v251, s[24:27], 0 offen sc1
L_o5:
    v_and_b32 v225, 0xffff0000, v225
    v_cvt_pk_bf16_f32 v227, v226, v227
    v_lshlrev_b32 v226, 16, v227
    ds_read_b128 v[220:223], v6 offset:32768
    v_mfma_f32_32x32x16_bf16 v[160:175], v[88:91], v[196:199], v[160:175]
    v_and_b32 v227, 0xffff0000, v227
    v_cvt_pk_bf16_f32 v229, v228, v229
    v_lshlrev_b32 v228, 16, v229
    v_and_b32 v229, 0xffff0000, v229
    v_cvt_pk_bf16_f32 v231, v230, v231
    v_lshlrev_b32 v230, 16, v231
    ds_read_b128 v[192:195], v7 offset:40960
    s_waitcnt lgkmcnt(9)
    v_mfma_f32_32x32x16_bf16 v[176:191], v[92:95], v[200:203], v[176:191]
    s_mov_b32 s69, 135168
    buffer_load_dwordx4 v[112:115], v253, s[56:59], s69 offen sc1
    s_add_u32 m0, s70, 40960
    s_mov_b32 s67, 57344
    buffer_load_dwordx4 v2, s[92:95], s67 offen lds
    v_and_b32 v231, 0xffff0000, v231
    ds_read_b128 v[196:199], v6 offset:40960
    s_waitcnt lgkmcnt(6)
    v_mfma_f32_32x32x16_bf16 v[160:175], v[92:95], v[204:207], v[160:175]
    v_add_u32 v7, 4294868992, v7
    ds_read_b128 v[200:203], v7 offset:0
    s_waitcnt vmcnt(9) lgkmcnt(6)
    v_mfma_f32_32x32x16_bf16 v[176:191], v[96:99], v[208:211], v[176:191]
    s_mov_b32 s69, 163840
    buffer_load_dwordx4 v[116:119], v253, s[56:59], s69 offen sc1
    s_add_u32 m0, s70, 49152
    s_mov_b32 s67, 860160
    buffer_load_dwordx4 v2, s[92:95], s67 offen lds
    v_add_u32 v6, 4294868992, v6
    ds_read_b128 v[204:207], v6 offset:0
    s_waitcnt lgkmcnt(6)
    v_mfma_f32_32x32x16_bf16 v[160:175], v[96:99], v[212:215], v[160:175]
    s_waitcnt vmcnt(6)
    s_cmp_lg_u32 s64, 6
    s_cbranch_scc1 L_fok14
    s_waitcnt vmcnt(4)
    v_cmp_lt_u32 vcc, 0, v252
    s_nop 4
    s_cbranch_vccnz L_fw14
L_fok14:
    s_barrier
    ds_read_b128 v[208:211], v7 offset:8192
    s_waitcnt lgkmcnt(6)
    v_mfma_f32_32x32x16_bf16 v[176:191], v[100:103], v[216:219], v[176:191]
    s_mov_b32 s69, 139264
    buffer_load_dwordx4 v[120:123], v253, s[56:59], s69 offen sc1
    s_add_u32 m0, s70, 57344
    s_mov_b32 s67, 172032
    buffer_load_dwordx4 v2, s[92:95], s67 offen lds
    ds_read_b128 v[212:215], v6 offset:8192
    s_waitcnt lgkmcnt(6)
    v_mfma_f32_32x32x16_bf16 v[160:175], v[100:103], v[220:223], v[160:175]
    ds_read_b128 v[216:219], v7 offset:16384
    s_waitcnt lgkmcnt(6)
    v_mfma_f32_32x32x16_bf16 v[176:191], v[104:107], v[192:195], v[176:191]
    s_mov_b32 s69, 167936
    buffer_load_dwordx4 v[124:127], v253, s[56:59], s69 offen sc1
    s_add_u32 m0, s70, 65536
    s_mov_b32 s67, 974848
    buffer_load_dwordx4 v2, s[92:95], s67 offen lds
    ds_read_b128 v[220:223], v6 offset:16384
    s_waitcnt lgkmcnt(6)
    v_mfma_f32_32x32x16_bf16 v[160:175], v[104:107], v[196:199], v[160:175]
    ds_read_b128 v[192:195], v7 offset:24576
    s_waitcnt vmcnt(9) lgkmcnt(6)
    v_mfma_f32_32x32x16_bf16 v[176:191], v[108:111], v[200:203], v[176:191]
    s_mov_b32 s69, 4096
    buffer_load_dwordx4 v[16:19], v253, s[56:59], s69 offen sc1
    s_add_u32 m0, s70, 73728
    s_mov_b32 s67, 286720
    buffer_load_dwordx4 v2, s[92:95], s67 offen lds
    ds_read_b128 v[196:199], v6 offset:24576
    s_waitcnt lgkmcnt(6)
    v_mfma_f32_32x32x16_bf16 v[160:175], v[108:111], v[204:207], v[160:175]
    s_waitcnt vmcnt(6)
    s_barrier
    ds_read_b128 v[200:203], v7 offset:32768
    s_waitcnt lgkmcnt(6)
    v_mfma_f32_32x32x16_bf16 v[176:191], v[112:115], v[208:211], v[176:191]
    s_mov_b32 s69, 61440
    buffer_load_dwordx4 v[20:23], v253, s[56:59], s69 offen sc1
    s_add_u32 m0, s70, 81920
    s_mov_b32 s67, 1089536
    buffer_load_dwordx4 v2, s[92:95], s67 offen lds
    ds_read_b128 v[204:207], v6 offset:32768
    s_waitcnt lgkmcnt(6)
    v_mfma_f32_32x32x16_bf16 v[160:175], v[112:115], v[212:215], v[160:175]
    v_add_u32 v5, 4294918144, v5
    ds_read_b64_tr_b16 v[208:209], v5 offset:40960
    ds_read_b64_tr_b16 v[210:211], v5 offset:41472
    s_waitcnt lgkmcnt(7)
    v_mfma_f32_32x32x16_bf16 v[176:191], v[116:119], v[216:219], v[176:191]
    s_mov_b32 s69, 12288
    buffer_load_dwordx4 v[24:27], v253, s[56:59], s69 offen sc1
    s_add_u32 m0, s70, 90112
    s_mov_b32 s67, 401408
    buffer_load_dwordx4 v2, s[92:95], s67 offen lds
    v_add_u32 v4, 4294918144, v4
    ds_read_b64_tr_b16 v[212:213], v4 offset:40960
    ds_read_b64_tr_b16 v[214:215], v4 offset:41472
    s_waitcnt lgkmcnt(8)
    v_mfma_f32_32x32x16_bf16 v[160:175], v[116:119], v[220:223], v[160:175]
    ds_read_b64_tr_b16 v[216:217], v5 offset:49152
    ds_read_b64_tr_b16 v[218:219], v5 offset:49664
    s_waitcnt vmcnt(9) lgkmcnt(9)
    v_mfma_f32_32x32x16_bf16 v[176:191], v[120:123], v[192:195], v[176:191]
    s_mov_b32 s69, 69632
    buffer_load_dwordx4 v[28:31], v253, s[56:59], s69 offen sc1
    s_add_u32 m0, s70, 98304
    s_mov_b32 s67, 1204224
    buffer_load_dwordx4 v2, s[92:95], s67 offen lds
    ds_read_b64_tr_b16 v[220:221], v4 offset:49152
    ds_read_b64_tr_b16 v[222:223], v4 offset:49664
    s_waitcnt lgkmcnt(10)
    v_mfma_f32_32x32x16_bf16 v[160:175], v[120:123], v[196:199], v[160:175]
    s_waitcnt vmcnt(6)
    s_barrier
    ds_read_b64_tr_b16 v[192:193], v5 offset:57344
    ds_read_b64_tr_b16 v[194:195], v5 offset:57856
    s_waitcnt lgkmcnt(11)
    v_mfma_f32_32x32x16_bf16 v[176:191], v[124:127], v[200:203], v[176:191]
    s_mov_b32 s69, 20480
    buffer_load_dwordx4 v[32:35], v253, s[56:59], s69 offen sc1
    s_add_u32 m0, s70, 106496
    s_mov_b32 s67, 516096
    buffer_load_dwordx4 v2, s[92:95], s67 offen lds
    ds_read_b64_tr_b16 v[196:197], v4 offset:57344
    ds_read_b64_tr_b16 v[198:199], v4 offset:57856
    s_waitcnt lgkmcnt(12)
    v_mfma_f32_32x32x16_bf16 v[160:175], v[124:127], v[204:207], v[160:175]
    v_add_u32 v5, 49152, v5
    ds_read_b64_tr_b16 v[200:201], v5 offset:16384
    ds_read_b64_tr_b16 v[202:203], v5 offset:16896
    s_waitcnt lgkmcnt(12)
    v_mfma_f32_32x32x16_bf16 v[144:159], v[16:19], v[208:211], v[144:159]
    s_mov_b32 s69, 77824
    buffer_load_dwordx4 v[36:39], v253, s[56:59], s69 offen sc1
    s_add_u32 m0, s70, 114688
    s_mov_b32 s67, 1318912
    buffer_load_dwordx4 v2, s[92:95], s67 offen lds
    v_add_u32 v4, 49152, v4
    ds_read_b64_tr_b16 v[204:205], v4 offset:16384
    ds_read_b64_tr_b16 v[206:207], v4 offset:16896
    s_waitcnt lgkmcnt(12)
    v_mfma_f32_32x32x16_bf16 v[128:143], v[16:19], v[212:215], v[128:143]
    ds_read_b64_tr_b16 v[208:209], v5 offset:24576
    ds_read_b64_tr_b16 v[210:211], v5 offset:25088
    s_waitcnt vmcnt(9) lgkmcnt(12)
    v_mfma_f32_32x32x16_bf16 v[144:159], v[20:23], v[216:219], v[144:159]
    s_mov_b32 s69, 28672
    buffer_load_dwordx4 v[40:43], v253, s[56:59], s69 offen sc1
    s_add_u32 m0, s70, 122880
    s_mov_b32 s67, 630784
    buffer_load_dwordx4 v2, s[92:95], s67 offen lds
    v_xor_b32 v254, 64, v13
    ds_read_b128 v[104:107], v254 offset:0
    ds_read_b128 v[112:115], v254 offset:256
    ds_read_b128 v[108:111], v254 offset:32
    ds_read_b128 v[116:119], v254 offset:288
    v_add_f32 v160, v160, v224
    ds_read_b64_tr_b16 v[212:213], v4 offset:24576
    ds_read_b64_tr_b16 v[214:215], v4 offset:25088
    s_waitcnt lgkmcnt(15)
    v_mfma_f32_32x32x16_bf16 v[128:143], v[20:23], v[220:223], v[128:143]
    v_add_f32 v161, v161, v225
    v_add_f32 v162, v162, v226
    v_add_f32 v163, v163, v227
    v_add_f32 v164, v164, v228
    v_add_f32 v165, v165, v229
    v_add_f32 v166, v166, v230
    s_waitcnt vmcnt(6)
    s_barrier
    ds_read_b64_tr_b16 v[216:217], v5 offset:32768
    ds_read_b64_tr_b16 v[218:219], v5 offset:33280
    s_waitcnt lgkmcnt(15)
    v_mfma_f32_32x32x16_bf16 v[144:159], v[24:27], v[192:195], v[144:159]
    s_mov_b32 s69, 86016
    buffer_load_dwordx4 v[44:47], v253, s[56:59], s69 offen sc1
    s_add_u32 m0, s70, 131072
    s_mov_b32 s67, 1433600
    buffer_load_dwordx4 v2, s[92:95], s67 offen lds
    v_add_f32 v167, v167, v231
    v_mul_f32 v160, v160, v232
    v_mul_f32 v161, v161, v233
    v_mul_f32 v162, v162, v234
    ds_read_b64_tr_b16 v[220:221], v4 offset:32768
    ds_read_b64_tr_b16 v[222:223], v4 offset:33280
    s_waitcnt lgkmcnt(15)
    v_mfma_f32_32x32x16_bf16 v[128:143], v[24:27], v[196:199], v[128:143]
    v_mul_f32 v163, v163, v235
    v_mul_f32 v164, v164, v236
    v_mul_f32 v165, v165, v237
    v_mul_f32 v166, v166, v238
    v_mul_f32 v167, v167, v239
    s_waitcnt lgkmcnt(9)
    v_mul_f32 v168, v168, v104
    ds_read_b64_tr_b16 v[192:193], v5 offset:40960
    ds_read_b64_tr_b16 v[194:195], v5 offset:41472
    v_mfma_f32_32x32x16_bf16 v[144:159], v[28:31], v[200:203], v[144:159]
    s_mov_b32 s69, 36864
    buffer_load_dwordx4 v[48:51], v253, s[56:59], s69 offen sc1
    s_add_u32 m0, s70, 139264
    s_mov_b32 s67, 745472
    buffer_load_dwordx4 v2, s[92:95], s67 offen lds
    v_mul_f32 v169, v169, v105
    v_mul_f32 v170, v170, v106
    v_mul_f32 v171, v171, v107
    s_waitcnt lgkmcnt(9)
    v_mul_f32 v172, v172, v108
    ds_read_b64_tr_b16 v[196:197], v4 offset:40960
    ds_read_b64_tr_b16 v[198:199], v4 offset:41472
    v_mfma_f32_32x32x16_bf16 v[128:143], v[28:31], v[204:207], v[128:143]
    v_mul_f32 v173, v173, v109
    v_mul_f32 v174, v174, v110
    v_mul_f32 v175, v175, v111
    v_mul_f32 v176, v176, v232
    v_mul_f32 v177, v177, v233
    v_mul_f32 v178, v178, v234
    ds_read_b64_tr_b16 v[200:201], v5 offset:49152
    ds_read_b64_tr_b16 v[202:203], v5 offset:49664
    s_waitcnt vmcnt(9)
    v_mfma_f32_32x32x16_bf16 v[144:159], v[32:35], v[208:211], v[144:159]
    s_mov_b32 s69, 94208
    buffer_load_dwordx4 v[52:55], v253, s[56:59], s69 offen sc1
    s_add_u32 m0, s70, 0
    s_mov_b32 s67, 1548288
    buffer_load_dwordx4 v2, s[92:95], s67 offen lds
    v_mul_f32 v179, v179, v235
    v_mul_f32 v180, v180, v236
    v_mul_f32 v181, v181, v237
    v_mul_f32 v182, v182, v238
    ds_read_b64_tr_b16 v[204:205], v4 offset:49152
    ds_read_b64_tr_b16 v[206:207], v4 offset:49664
    s_waitcnt lgkmcnt(12)
    v_mfma_f32_32x32x16_bf16 v[128:143], v[32:35], v[212:215], v[128:143]
    v_mul_f32 v183, v183, v239
    v_mul_f32 v184, v184, v104
    v_mul_f32 v185, v185, v105
    v_mul_f32 v186, v186, v106
    v_mul_f32 v187, v187, v107
    v_mul_f32 v188, v188, v108
    s_waitcnt vmcnt(6)
    s_barrier
    ds_read_b64_tr_b16 v[208:209], v5 offset:57344
    ds_read_b64_tr_b16 v[210:211], v5 offset:57856
    s_waitcnt lgkmcnt(12)
    v_mfma_f32_32x32x16_bf16 v[144:159], v[36:39], v[216:219], v[144:159]
    s_mov_b32 s69, 45056
    buffer_load_dwordx4 v[56:59], v253, s[56:59], s69 offen sc1
    v_mul_f32 v189, v189, v109
    v_mul_f32 v190, v190, v110
    v_mul_f32 v191, v191, v111
    ds_read_b64_tr_b16 v[212:213], v4 offset:57344
    ds_read_b64_tr_b16 v[214:215], v4 offset:57856
    s_waitcnt lgkmcnt(12)
    v_mfma_f32_32x32x16_bf16 v[128:143], v[36:39], v[220:223], v[128:143]
    v_add_u32 v5, 49152, v5
    ds_read_b64_tr_b16 v[216:217], v5 offset:16384
    ds_read_b64_tr_b16 v[218:219], v5 offset:16896
    s_waitcnt lgkmcnt(12)
    v_mfma_f32_32x32x16_bf16 v[144:159], v[40:43], v[192:195], v[144:159]
    s_mov_b32 s69, 102400
    buffer_load_dwordx4 v[60:63], v253, s[56:59], s69 offen sc1
    v_add_u32 v4, 49152, v4
    ds_read_b64_tr_b16 v[220:221], v4 offset:16384
    ds_read_b64_tr_b16 v[222:223], v4 offset:16896
    s_waitcnt lgkmcnt(12)
    v_mfma_f32_32x32x16_bf16 v[128:143], v[40:43], v[196:199], v[128:143]
    ds_read_b64_tr_b16 v[192:193], v5 offset:24576
    ds_read_b64_tr_b16 v[194:195], v5 offset:25088
    s_waitcnt vmcnt(7) lgkmcnt(12)
    v_mfma_f32_32x32x16_bf16 v[144:159], v[44:47], v[200:203], v[144:159]
    s_mov_b32 s69, 53248
    buffer_load_dwordx4 v[64:67], v253, s[56:59], s69 offen sc1
    ds_read_b64_tr_b16 v[196:197], v4 offset:24576
    ds_read_b64_tr_b16 v[198:199], v4 offset:25088
    s_waitcnt lgkmcnt(12)
    v_mfma_f32_32x32x16_bf16 v[128:143], v[44:47], v[204:207], v[128:143]
    s_waitcnt vmcnt(3)
    s_barrier
    ds_read_b64_tr_b16 v[200:201], v5 offset:32768
    ds_read_b64_tr_b16 v[202:203], v5 offset:33280
    s_waitcnt lgkmcnt(12)
    v_mfma_f32_32x32x16_bf16 v[144:159], v[48:51], v[208:211], v[144:159]
    s_mov_b32 s69, 110592
    buffer_load_dwordx4 v[68:71], v253, s[56:59], s69 offen sc1
    ds_read_b64_tr_b16 v[204:205], v4 offset:32768
    ds_read_b64_tr_b16 v[206:207], v4 offset:33280
    s_waitcnt lgkmcnt(12)
    v_mfma_f32_32x32x16_bf16 v[128:143], v[48:51], v[212:215], v[128:143]
    ds_read_b64_tr_b16 v[208:209], v5 offset:40960
    ds_read_b64_tr_b16 v[210:211], v5 offset:41472
    s_waitcnt lgkmcnt(12)
    v_mfma_f32_32x32x16_bf16 v[144:159], v[52:55], v[216:219], v[144:159]
    ds_read_b64_tr_b16 v[212:213], v4 offset:40960
    ds_read_b64_tr_b16 v[214:215], v4 offset:41472
    s_waitcnt lgkmcnt(12)
    v_mfma_f32_32x32x16_bf16 v[128:143], v[52:55], v[220:223], v[128:143]
    v_add_u32 v5, 4294868992, v5
    ds_read_b64_tr_b16 v[216:217], v5 offset:0
    ds_read_b64_tr_b16 v[218:219], v5 offset:512
    s_waitcnt vmcnt(3) lgkmcnt(12)
    v_mfma_f32_32x32x16_bf16 v[144:159], v[56:59], v[192:195], v[144:159]
    v_add_u32 v4, 4294868992, v4
    ds_read_b64_tr_b16 v[220:221], v4 offset:0
    ds_read_b64_tr_b16 v[222:223], v4 offset:512
    s_waitcnt lgkmcnt(12)
    v_mfma_f32_32x32x16_bf16 v[128:143], v[56:59], v[196:199], v[128:143]
    s_waitcnt vmcnt(2) lgkmcnt(10)
    v_mfma_f32_32x32x16_bf16 v[144:159], v[60:63], v[200:203], v[144:159]
    s_waitcnt lgkmcnt(8)
    v_mfma_f32_32x32x16_bf16 v[128:143], v[60:63], v[204:207], v[128:143]
    s_waitcnt vmcnt(1) lgkmcnt(6)
    v_mfma_f32_32x32x16_bf16 v[144:159], v[64:67], v[208:211], v[144:159]
    s_waitcnt lgkmcnt(4)
    v_mfma_f32_32x32x16_bf16 v[128:143], v[64:67], v[212:215], v[128:143]
    s_waitcnt vmcnt(0) lgkmcnt(2)
    v_mfma_f32_32x32x16_bf16 v[144:159], v[68:71], v[216:219], v[144:159]
    s_waitcnt lgkmcnt(0)
    v_mfma_f32_32x32x16_bf16 v[128:143], v[68:71], v[220:223], v[128:143]
    s_nop 9
    v_fma_f32 v144, v144, v240, v176
    v_fma_f32 v145, v145, v241, v177
    v_fma_f32 v146, v146, v242, v178
    v_fma_f32 v147, v147, v243, v179
    ds_write_b128 v9, v[144:147] offset:49152
    v_fma_f32 v148, v148, v244, v180
    v_fma_f32 v149, v149, v245, v181
    v_fma_f32 v150, v150, v246, v182
    v_fma_f32 v151, v151, v247, v183
    ds_write_b128 v9, v[148:151] offset:50176
    v_fma_f32 v152, v152, v112, v184
    v_fma_f32 v153, v153, v113, v185
    v_fma_f32 v154, v154, v114, v186
    v_fma_f32 v155, v155, v115, v187
    ds_write_b128 v10, v[152:155] offset:49152
    v_fma_f32 v156, v156, v116, v188
    v_fma_f32 v157, v157, v117, v189
    v_fma_f32 v158, v158, v118, v190
    v_fma_f32 v159, v159, v119, v191
    ds_write_b128 v10, v[156:159] offset:50176
    v_fma_f32 v136, v136, v112, v168
    v_fma_f32 v137, v137, v113, v169
    v_fma_f32 v138, v138, v114, v170
    v_fma_f32 v139, v139, v115, v171
    ds_write_b128 v8, v[136:139] offset:49152
    v_fma_f32 v140, v140, v116, v172
    v_fma_f32 v141, v141, v117, v173
    v_fma_f32 v142, v142, v118, v174
    v_fma_f32 v143, v143, v119, v175
    ds_write_b128 v8, v[140:143] offset:50176
    v_fma_f32 v128, v128, v240, v160
    v_fma_f32 v129, v129, v241, v161
    v_fma_f32 v130, v130, v242, v162
    v_fma_f32 v131, v131, v243, v163
    v_fma_f32 v132, v132, v244, v164
    v_fma_f32 v133, v133, v245, v165
    v_fma_f32 v134, v134, v246, v166
    v_fma_f32 v135, v135, v247, v167
    s_waitcnt lgkmcnt(0)
    s_barrier
    ds_read_b128 v[80:83], v15 offset:49152
    ds_read_b128 v[84:87], v15 offset:50176
    ds_read_b128 v[88:91], v15 offset:51200
    ds_read_b128 v[92:95], v15 offset:52224
    ds_read_b128 v[96:99], v15 offset:53248
    ds_read_b128 v[100:103], v15 offset:54272
    s_waitcnt lgkmcnt(3)
    v_add_f32 v80, v80, v88
    v_add_f32 v81, v81, v89
    v_add_f32 v82, v82, v90
    v_add_f32 v83, v83, v91
    s_waitcnt lgkmcnt(2)
    v_add_f32 v84, v84, v92
    v_add_f32 v85, v85, v93
    v_add_f32 v86, v86, v94
    v_add_f32 v87, v87, v95
    s_waitcnt lgkmcnt(1)
    v_add_f32 v128, v128, v96
    v_add_f32 v129, v129, v97
    v_add_f32 v130, v130, v98
    v_add_f32 v131, v131, v99
    s_waitcnt lgkmcnt(0)
    v_add_f32 v132, v132, v100
    v_add_f32 v133, v133, v101
    v_add_f32 v134, v134, v102
    v_add_f32 v135, v135, v103
    v_add_f32 v128, v128, v80
    v_add_f32 v129, v129, v81
    s_mov_b32 s67, 0
    buffer_store_dword v128, v14, s[48:51], s67 offen offset:0
    buffer_store_dword v129, v14, s[48:51], s67 offen offset:1792
    v_add_f32 v130, v130, v82
    v_add_f32 v131, v131, v83
    s_mov_b32 s67, 3584
    buffer_store_dword v130, v14, s[48:51], s67 offen offset:0
    buffer_store_dword v131, v14, s[48:51], s67 offen offset:1792
    v_add_f32 v132, v132, v84
    v_add_f32 v133, v133, v85
    s_mov_b32 s67, 14336
    buffer_store_dword v132, v14, s[48:51], s67 offen offset:0
    buffer_store_dword v133, v14, s[48:51], s67 offen offset:1792
    v_add_f32 v134, v134, v86
    v_add_f32 v135, v135, v87
    s_mov_b32 s67, 17920
    buffer_store_dword v134, v14, s[48:51], s67 offen offset:0
    buffer_store_dword v135, v14, s[48:51], s67 offen offset:1792
    s_endpgm
L_ew:
    s_add_u32 s72, s72, 1
    s_cmp_gt_u32 s72, 200000
    s_cbranch_scc1 L_eok
    s_sleep 2
    buffer_load_dwordx2 v[152:153], v250, s[60:63], 0 offen offset:0 sc1
    buffer_load_dwordx2 v[154:155], v250, s[60:63], 0 offen offset:128 sc1
    buffer_load_dwordx2 v[156:157], v250, s[60:63], 0 offen offset:256 sc1
    buffer_load_dwordx2 v[158:159], v250, s[60:63], 0 offen offset:384 sc1
    s_waitcnt vmcnt(0)
    s_branch L_eck
L_gw7:
    s_add_u32 s72, s72, 1
    s_cmp_gt_u32 s72, 200000
    s_cbranch_scc1 L_gok7
    s_sleep 4
    v_mov_b32 v252, 0
    buffer_load_dword v252, v252, s[8:11], 0 offen sc1
    s_waitcnt vmcnt(0)
    v_readfirstlane_b32 s68, v252
    s_nop 0
    s_cmp_lg_u32 s68, 1
    s_cbranch_scc1 L_gw7
    s_branch L_gok7
L_fw12:
    s_add_u32 s72, s72, 1
    s_cmp_gt_u32 s72, 200000
    s_cbranch_scc1 L_fok12
    s_sleep 1
    buffer_load_dword v252, v251, s[24:27], 0 offen sc1
    s_waitcnt vmcnt(0)
    v_cmp_lt_u32 vcc, 2, v252
    s_nop 4
    s_cbranch_vccnz L_fw12
    s_branch L_fok12
L_fw13:
    s_add_u32 s72, s72, 1
    s_cmp_gt_u32 s72, 200000
    s_cbranch_scc1 L_fok13
    s_sleep 1
    buffer_load_dword v252, v251, s[24:27], 0 offen sc1
    s_waitcnt vmcnt(0)
    v_cmp_lt_u32 vcc, 1, v252
    s_nop 4
    s_cbranch_vccnz L_fw13
    s_branch L_fok13
L_fw14:
    s_add_u32 s72, s72, 1
    s_cmp_gt_u32 s72, 200000
    s_cbranch_scc1 L_fok14
    s_sleep 1
    buffer_load_dword v252, v251, s[24:27], 0 offen sc1
    s_waitcnt vmcnt(0)
    v_cmp_lt_u32 vcc, 0, v252
    s_nop 4
    s_cbranch_vccnz L_fw14
    s_branch L_fok14
L_gw15:
    s_add_u32 s72, s72, 1
    s_cmp_gt_u32 s72, 200000
    s_cbranch_scc1 L_gok15
    s_sleep 4
    s_lshr_b32 s68, s75, 1
    s_lshl_b32 s68, s68, 7
    v_mov_b32 v252, s68
    buffer_load_dword v252, v252, s[24:27], 0 offen offset:2052 sc1
    s_waitcnt vmcnt(0)
    v_readfirstlane_b32 s68, v252
    s_nop 0
    s_cmp_lg_u32 s68, 1
    s_cbranch_scc1 L_gw15
    s_branch L_gok15
L_aux:
    v_lshlrev_b32 v2, 4, v0
    v_lshlrev_b32 v9, 7, v0
    v_mov_b32 v3, 2147483632
    v_cmp_gt_u32 vcc, 56, v0
    s_nop 1
    v_cndmask_b32 v3, v3, v2, vcc
    v_mov_b32 v4, 2147483632
    v_cmp_eq_u32 vcc, 0, v0
    s_nop 1
    v_cndmask_b32 v10, v4, v0, vcc
    v_mov_b32 v11, 1
    s_waitcnt lgkmcnt(0)
    s_mov_b32 s92, s34
    s_mov_b32 s93, s35
    s_mov_b32 s94, 256
    s_mov_b32 s95, 0x00020000
    s_add_u32 s8, s36, 11026432
    s_addc_u32 s9, s37, 0
    s_mov_b32 s10, 65536
    s_mov_b32 s11, 0x00020000
    s_cmp_lg_u32 s2, 0
    s_cbranch_scc1 L_aux_noclr
    v_mov_b32 v4, -1
    v_mov_b32 v5, -1
    v_mov_b32 v6, -1
    v_mov_b32 v7, -1
    s_lshl_b32 s68, s64, 13
    buffer_store_dwordx4 v[4:7], v2, s[8:11], s68 offen offset:0 sc1
    buffer_store_dwordx4 v[4:7], v2, s[8:11], s68 offen offset:1024 sc1
    buffer_store_dwordx4 v[4:7], v2, s[8:11], s68 offen offset:2048 sc1
    buffer_store_dwordx4 v[4:7], v2, s[8:11], s68 offen offset:3072 sc1
    s_add_u32 s68, s68, 4096
    buffer_store_dwordx4 v[4:7], v2, s[8:11], s68 offen offset:0 sc1
    buffer_store_dwordx4 v[4:7], v2, s[8:11], s68 offen offset:1024 sc1
    buffer_store_dwordx4 v[4:7], v2, s[8:11], s68 offen offset:2048 sc1
    buffer_store_dwordx4 v[4:7], v2, s[8:11], s68 offen offset:3072 sc1
    s_waitcnt vmcnt(0)
    s_barrier
    s_cmp_lg_u32 s64, 0
    s_cbranch_scc1 L_aux_noclr
    buffer_store_dword v11, v10, s[92:95], 0 offen sc1
L_aux_noclr:
    s_mov_b32 s40, s4
    s_mov_b32 s41, s5
    s_mov_b32 s42, 1835008
    s_mov_b32 s43, 0x00020000
    s_mov_b32 s60, s30
    s_mov_b32 s61, s31
    s_mov_b32 s62, 896
    s_mov_b32 s63, 0x00020000
    s_lshl_b32 s66, s2, 3
    s_add_u32 s66, s66, s64
    s_mul_i32 s68, s66, 7168
    buffer_load_dwordx4 v[32:35], v3, s[40:43], s68 offen offset:0
    buffer_load_dwordx4 v[36:39], v3, s[40:43], s68 offen offset:896
    buffer_load_dwordx4 v[40:43], v3, s[40:43], s68 offen offset:1792
    buffer_load_dwordx4 v[44:47], v3, s[40:43], s68 offen offset:2688
    s_add_u32 s68, s68, 3584
    buffer_load_dwordx4 v[48:51], v3, s[40:43], s68 offen offset:0
    buffer_load_dwordx4 v[52:55], v3, s[40:43], s68 offen offset:896
    buffer_load_dwordx4 v[56:59], v3, s[40:43], s68 offen offset:1792
    buffer_load_dwordx4 v[60:63], v3, s[40:43], s68 offen offset:2688
    buffer_load_dwordx4 v[16:19], v3, s[60:63], 0 offen
    s_add_u32 s56, s36, 11010048
    s_addc_u32 s57, s37, 0
    s_mov_b32 s58, 16384
    s_mov_b32 s59, 0x00020000
    s_mov_b32 s44, s28
    s_mov_b32 s45, s29
    s_mov_b32 s46, 1605632
    s_mov_b32 s47, 0x00020000
    s_mov_b32 s48, s14
    s_mov_b32 s49, s15
    s_mov_b32 s50, 401408
    s_mov_b32 s51, 0x00020000
    s_mov_b32 s52, s16
    s_mov_b32 s53, s17
    s_mov_b32 s54, 401408
    s_mov_b32 s55, 0x00020000
    s_waitcnt vmcnt(0)
    v_lshlrev_b32 v20, 16, v16
    v_and_b32 v21, 0xffff0000, v16
    v_lshlrev_b32 v22, 16, v17
    v_and_b32 v23, 0xffff0000, v17
    v_lshlrev_b32 v24, 16, v18
    v_and_b32 v25, 0xffff0000, v18
    v_lshlrev_b32 v26, 16, v19
    v_and_b32 v27, 0xffff0000, v19
    global_load_dword v255, v254, s[96:97] sc1
    s_mov_b32 s40, s26
    s_mov_b32 s41, s27
    s_mov_b32 s42, 1605632
    s_mov_b32 s43, 0x00020000
    v_min_u32 v14, 48, v0
    v_lshlrev_b32 v14, 7, v14
    s_mul_i32 s68, s66, 6272
    buffer_load_dword v66, v14, s[40:43], s68 offen
    s_mov_b32 s40, s24
    s_mov_b32 s41, s25
    v_min_u32 v14, 24, v0
    v_lshlrev_b32 v14, 8, v14
    s_mul_i32 s68, s66, 6400
    buffer_load_dword v67, v14, s[40:43], s68 offen offset:128
    v_lshlrev_b32 v28, 16, v32
    v_and_b32 v29, 0xffff0000, v32
    v_mul_f32 v28, v28, v20
    v_mul_f32 v29, v29, v21
    v_cvt_pk_bf16_f32 v29, v28, v29
    v_lshlrev_b32 v28, 16, v29
    v_and_b32 v29, 0xffff0000, v29
    v_add_f32 v112, v28, v29
    v_lshlrev_b32 v28, 16, v33
    v_and_b32 v29, 0xffff0000, v33
    v_mul_f32 v28, v28, v22
    v_mul_f32 v29, v29, v23
    v_cvt_pk_bf16_f32 v29, v28, v29
    v_lshlrev_b32 v28, 16, v29
    v_and_b32 v29, 0xffff0000, v29
    v_add_f32 v112, v112, v28
    v_add_f32 v112, v112, v29
    v_lshlrev_b32 v28, 16, v34
    v_and_b32 v29, 0xffff0000, v34
    v_mul_f32 v28, v28, v24
    v_mul_f32 v29, v29, v25
    v_cvt_pk_bf16_f32 v29, v28, v29
    v_lshlrev_b32 v28, 16, v29
    v_and_b32 v29, 0xffff0000, v29
    v_add_f32 v112, v112, v28
    v_add_f32 v112, v112, v29
    v_lshlrev_b32 v28, 16, v35
    v_and_b32 v29, 0xffff0000, v35
    v_mul_f32 v28, v28, v26
    v_mul_f32 v29, v29, v27
    v_cvt_pk_bf16_f32 v29, v28, v29
    v_lshlrev_b32 v28, 16, v29
    v_and_b32 v29, 0xffff0000, v29
    v_add_f32 v112, v112, v28
    v_add_f32 v112, v112, v29
    v_lshlrev_b32 v28, 16, v36
    v_and_b32 v29, 0xffff0000, v36
    v_mul_f32 v28, v28, v20
    v_mul_f32 v29, v29, v21
    v_cvt_pk_bf16_f32 v29, v28, v29
    v_lshlrev_b32 v28, 16, v29
    v_and_b32 v29, 0xffff0000, v29
    v_add_f32 v113, v28, v29
    v_lshlrev_b32 v28, 16, v37
    v_and_b32 v29, 0xffff0000, v37
    v_mul_f32 v28, v28, v22
    v_mul_f32 v29, v29, v23
    v_cvt_pk_bf16_f32 v29, v28, v29
    v_lshlrev_b32 v28, 16, v29
    v_and_b32 v29, 0xffff0000, v29
    v_add_f32 v113, v113, v28
    v_add_f32 v113, v113, v29
    v_lshlrev_b32 v28, 16, v38
    v_and_b32 v29, 0xffff0000, v38
    v_mul_f32 v28, v28, v24
    v_mul_f32 v29, v29, v25
    v_cvt_pk_bf16_f32 v29, v28, v29
    v_lshlrev_b32 v28, 16, v29
    v_and_b32 v29, 0xffff0000, v29
    v_add_f32 v113, v113, v28
    v_add_f32 v113, v113, v29
    v_lshlrev_b32 v28, 16, v39
    v_and_b32 v29, 0xffff0000, v39
    v_mul_f32 v28, v28, v26
    v_mul_f32 v29, v29, v27
    v_cvt_pk_bf16_f32 v29, v28, v29
    v_lshlrev_b32 v28, 16, v29
    v_and_b32 v29, 0xffff0000, v29
    v_add_f32 v113, v113, v28
    v_add_f32 v113, v113, v29
    v_lshlrev_b32 v28, 16, v40
    v_and_b32 v29, 0xffff0000, v40
    v_mul_f32 v28, v28, v20
    v_mul_f32 v29, v29, v21
    v_cvt_pk_bf16_f32 v29, v28, v29
    v_lshlrev_b32 v28, 16, v29
    v_and_b32 v29, 0xffff0000, v29
    v_add_f32 v114, v28, v29
    v_lshlrev_b32 v28, 16, v41
    v_and_b32 v29, 0xffff0000, v41
    v_mul_f32 v28, v28, v22
    v_mul_f32 v29, v29, v23
    v_cvt_pk_bf16_f32 v29, v28, v29
    v_lshlrev_b32 v28, 16, v29
    v_and_b32 v29, 0xffff0000, v29
    v_add_f32 v114, v114, v28
    v_add_f32 v114, v114, v29
    v_lshlrev_b32 v28, 16, v42
    v_and_b32 v29, 0xffff0000, v42
    v_mul_f32 v28, v28, v24
    v_mul_f32 v29, v29, v25
    v_cvt_pk_bf16_f32 v29, v28, v29
    v_lshlrev_b32 v28, 16, v29
    v_and_b32 v29, 0xffff0000, v29
    v_add_f32 v114, v114, v28
    v_add_f32 v114, v114, v29
    v_lshlrev_b32 v28, 16, v43
    v_and_b32 v29, 0xffff0000, v43
    v_mul_f32 v28, v28, v26
    v_mul_f32 v29, v29, v27
    v_cvt_pk_bf16_f32 v29, v28, v29
    v_lshlrev_b32 v28, 16, v29
    v_and_b32 v29, 0xffff0000, v29
    v_add_f32 v114, v114, v28
    v_add_f32 v114, v114, v29
    v_lshlrev_b32 v28, 16, v44
    v_and_b32 v29, 0xffff0000, v44
    v_mul_f32 v28, v28, v20
    v_mul_f32 v29, v29, v21
    v_cvt_pk_bf16_f32 v29, v28, v29
    v_lshlrev_b32 v28, 16, v29
    v_and_b32 v29, 0xffff0000, v29
    v_add_f32 v115, v28, v29
    v_lshlrev_b32 v28, 16, v45
    v_and_b32 v29, 0xffff0000, v45
    v_mul_f32 v28, v28, v22
    v_mul_f32 v29, v29, v23
    v_cvt_pk_bf16_f32 v29, v28, v29
    v_lshlrev_b32 v28, 16, v29
    v_and_b32 v29, 0xffff0000, v29
    v_add_f32 v115, v115, v28
    v_add_f32 v115, v115, v29
    v_lshlrev_b32 v28, 16, v46
    v_and_b32 v29, 0xffff0000, v46
    v_mul_f32 v28, v28, v24
    v_mul_f32 v29, v29, v25
    v_cvt_pk_bf16_f32 v29, v28, v29
    v_lshlrev_b32 v28, 16, v29
    v_and_b32 v29, 0xffff0000, v29
    v_add_f32 v115, v115, v28
    v_add_f32 v115, v115, v29
    v_lshlrev_b32 v28, 16, v47
    v_and_b32 v29, 0xffff0000, v47
    v_mul_f32 v28, v28, v26
    v_mul_f32 v29, v29, v27
    v_cvt_pk_bf16_f32 v29, v28, v29
    v_lshlrev_b32 v28, 16, v29
    v_and_b32 v29, 0xffff0000, v29
    v_add_f32 v115, v115, v28
    v_add_f32 v115, v115, v29
    v_lshlrev_b32 v28, 16, v48
    v_and_b32 v29, 0xffff0000, v48
    v_mul_f32 v28, v28, v20
    v_mul_f32 v29, v29, v21
    v_cvt_pk_bf16_f32 v29, v28, v29
    v_lshlrev_b32 v28, 16, v29
    v_and_b32 v29, 0xffff0000, v29
    v_add_f32 v116, v28, v29
    v_lshlrev_b32 v28, 16, v49
    v_and_b32 v29, 0xffff0000, v49
    v_mul_f32 v28, v28, v22
    v_mul_f32 v29, v29, v23
    v_cvt_pk_bf16_f32 v29, v28, v29
    v_lshlrev_b32 v28, 16, v29
    v_and_b32 v29, 0xffff0000, v29
    v_add_f32 v116, v116, v28
    v_add_f32 v116, v116, v29
    v_lshlrev_b32 v28, 16, v50
    v_and_b32 v29, 0xffff0000, v50
    v_mul_f32 v28, v28, v24
    v_mul_f32 v29, v29, v25
    v_cvt_pk_bf16_f32 v29, v28, v29
    v_lshlrev_b32 v28, 16, v29
    v_and_b32 v29, 0xffff0000, v29
    v_add_f32 v116, v116, v28
    v_add_f32 v116, v116, v29
    v_lshlrev_b32 v28, 16, v51
    v_and_b32 v29, 0xffff0000, v51
    v_mul_f32 v28, v28, v26
    v_mul_f32 v29, v29, v27
    v_cvt_pk_bf16_f32 v29, v28, v29
    v_lshlrev_b32 v28, 16, v29
    v_and_b32 v29, 0xffff0000, v29
    v_add_f32 v116, v116, v28
    v_add_f32 v116, v116, v29
    v_lshlrev_b32 v28, 16, v52
    v_and_b32 v29, 0xffff0000, v52
    v_mul_f32 v28, v28, v20
    v_mul_f32 v29, v29, v21
    v_cvt_pk_bf16_f32 v29, v28, v29
    v_lshlrev_b32 v28, 16, v29
    v_and_b32 v29, 0xffff0000, v29
    v_add_f32 v117, v28, v29
    v_lshlrev_b32 v28, 16, v53
    v_and_b32 v29, 0xffff0000, v53
    v_mul_f32 v28, v28, v22
    v_mul_f32 v29, v29, v23
    v_cvt_pk_bf16_f32 v29, v28, v29
    v_lshlrev_b32 v28, 16, v29
    v_and_b32 v29, 0xffff0000, v29
    v_add_f32 v117, v117, v28
    v_add_f32 v117, v117, v29
    v_lshlrev_b32 v28, 16, v54
    v_and_b32 v29, 0xffff0000, v54
    v_mul_f32 v28, v28, v24
    v_mul_f32 v29, v29, v25
    v_cvt_pk_bf16_f32 v29, v28, v29
    v_lshlrev_b32 v28, 16, v29
    v_and_b32 v29, 0xffff0000, v29
    v_add_f32 v117, v117, v28
    v_add_f32 v117, v117, v29
    v_lshlrev_b32 v28, 16, v55
    v_and_b32 v29, 0xffff0000, v55
    v_mul_f32 v28, v28, v26
    v_mul_f32 v29, v29, v27
    v_cvt_pk_bf16_f32 v29, v28, v29
    v_lshlrev_b32 v28, 16, v29
    v_and_b32 v29, 0xffff0000, v29
    v_add_f32 v117, v117, v28
    v_add_f32 v117, v117, v29
    v_lshlrev_b32 v28, 16, v56
    v_and_b32 v29, 0xffff0000, v56
    v_mul_f32 v28, v28, v20
    v_mul_f32 v29, v29, v21
    v_cvt_pk_bf16_f32 v29, v28, v29
    v_lshlrev_b32 v28, 16, v29
    v_and_b32 v29, 0xffff0000, v29
    v_add_f32 v118, v28, v29
    v_lshlrev_b32 v28, 16, v57
    v_and_b32 v29, 0xffff0000, v57
    v_mul_f32 v28, v28, v22
    v_mul_f32 v29, v29, v23
    v_cvt_pk_bf16_f32 v29, v28, v29
    v_lshlrev_b32 v28, 16, v29
    v_and_b32 v29, 0xffff0000, v29
    v_add_f32 v118, v118, v28
    v_add_f32 v118, v118, v29
    v_lshlrev_b32 v28, 16, v58
    v_and_b32 v29, 0xffff0000, v58
    v_mul_f32 v28, v28, v24
    v_mul_f32 v29, v29, v25
    v_cvt_pk_bf16_f32 v29, v28, v29
    v_lshlrev_b32 v28, 16, v29
    v_and_b32 v29, 0xffff0000, v29
    v_add_f32 v118, v118, v28
    v_add_f32 v118, v118, v29
    v_lshlrev_b32 v28, 16, v59
    v_and_b32 v29, 0xffff0000, v59
    v_mul_f32 v28, v28, v26
    v_mul_f32 v29, v29, v27
    v_cvt_pk_bf16_f32 v29, v28, v29
    v_lshlrev_b32 v28, 16, v29
    v_and_b32 v29, 0xffff0000, v29
    v_add_f32 v118, v118, v28
    v_add_f32 v118, v118, v29
    v_lshlrev_b32 v28, 16, v60
    v_and_b32 v29, 0xffff0000, v60
    v_mul_f32 v28, v28, v20
    v_mul_f32 v29, v29, v21
    v_cvt_pk_bf16_f32 v29, v28, v29
    v_lshlrev_b32 v28, 16, v29
    v_and_b32 v29, 0xffff0000, v29
    v_add_f32 v119, v28, v29
    v_lshlrev_b32 v28, 16, v61
    v_and_b32 v29, 0xffff0000, v61
    v_mul_f32 v28, v28, v22
    v_mul_f32 v29, v29, v23
    v_cvt_pk_bf16_f32 v29, v28, v29
    v_lshlrev_b32 v28, 16, v29
    v_and_b32 v29, 0xffff0000, v29
    v_add_f32 v119, v119, v28
    v_add_f32 v119, v119, v29
    v_lshlrev_b32 v28, 16, v62
    v_and_b32 v29, 0xffff0000, v62
    v_mul_f32 v28, v28, v24
    v_mul_f32 v29, v29, v25
    v_cvt_pk_bf16_f32 v29, v28, v29
    v_lshlrev_b32 v28, 16, v29
    v_and_b32 v29, 0xffff0000, v29
    v_add_f32 v119, v119, v28
    v_add_f32 v119, v119, v29
    v_lshlrev_b32 v28, 16, v63
    v_and_b32 v29, 0xffff0000, v63
    v_mul_f32 v28, v28, v26
    v_mul_f32 v29, v29, v27
    v_cvt_pk_bf16_f32 v29, v28, v29
    v_lshlrev_b32 v28, 16, v29
    v_and_b32 v29, 0xffff0000, v29
    v_add_f32 v119, v119, v28
    v_add_f32 v119, v119, v29
    v_add_f32_dpp v112, v112, v112 quad_perm:[1,0,3,2] row_mask:0xf bank_mask:0xf
    v_add_f32_dpp v113, v113, v113 quad_perm:[1,0,3,2] row_mask:0xf bank_mask:0xf
    v_add_f32_dpp v114, v114, v114 quad_perm:[1,0,3,2] row_mask:0xf bank_mask:0xf
    v_add_f32_dpp v115, v115, v115 quad_perm:[1,0,3,2] row_mask:0xf bank_mask:0xf
    v_add_f32_dpp v116, v116, v116 quad_perm:[1,0,3,2] row_mask:0xf bank_mask:0xf
    v_add_f32_dpp v117, v117, v117 quad_perm:[1,0,3,2] row_mask:0xf bank_mask:0xf
    v_add_f32_dpp v118, v118, v118 quad_perm:[1,0,3,2] row_mask:0xf bank_mask:0xf
    v_add_f32_dpp v119, v119, v119 quad_perm:[1,0,3,2] row_mask:0xf bank_mask:0xf
    v_add_f32_dpp v112, v112, v112 quad_perm:[2,3,0,1] row_mask:0xf bank_mask:0xf
    v_add_f32_dpp v113, v113, v113 quad_perm:[2,3,0,1] row_mask:0xf bank_mask:0xf
    v_add_f32_dpp v114, v114, v114 quad_perm:[2,3,0,1] row_mask:0xf bank_mask:0xf
    v_add_f32_dpp v115, v115, v115 quad_perm:[2,3,0,1] row_mask:0xf bank_mask:0xf
    v_add_f32_dpp v116, v116, v116 quad_perm:[2,3,0,1] row_mask:0xf bank_mask:0xf
    v_add_f32_dpp v117, v117, v117 quad_perm:[2,3,0,1] row_mask:0xf bank_mask:0xf
    v_add_f32_dpp v118, v118, v118 quad_perm:[2,3,0,1] row_mask:0xf bank_mask:0xf
    v_add_f32_dpp v119, v119, v119 quad_perm:[2,3,0,1] row_mask:0xf bank_mask:0xf
    v_add_f32_dpp v112, v112, v112 row_half_mirror row_mask:0xf bank_mask:0xf
    v_add_f32_dpp v113, v113, v113 row_half_mirror row_mask:0xf bank_mask:0xf
    v_add_f32_dpp v114, v114, v114 row_half_mirror row_mask:0xf bank_mask:0xf
    v_add_f32_dpp v115, v115, v115 row_half_mirror row_mask:0xf bank_mask:0xf
    v_add_f32_dpp v116, v116, v116 row_half_mirror row_mask:0xf bank_mask:0xf
    v_add_f32_dpp v117, v117, v117 row_half_mirror row_mask:0xf bank_mask:0xf
    v_add_f32_dpp v118, v118, v118 row_half_mirror row_mask:0xf bank_mask:0xf
    v_add_f32_dpp v119, v119, v119 row_half_mirror row_mask:0xf bank_mask:0xf
    v_add_f32_dpp v112, v112, v112 row_mirror row_mask:0xf bank_mask:0xf
    v_add_f32_dpp v113, v113, v113 row_mirror row_mask:0xf bank_mask:0xf
    v_add_f32_dpp v114, v114, v114 row_mirror row_mask:0xf bank_mask:0xf
    v_add_f32_dpp v115, v115, v115 row_mirror row_mask:0xf bank_mask:0xf
    v_add_f32_dpp v116, v116, v116 row_mirror row_mask:0xf bank_mask:0xf
    v_add_f32_dpp v117, v117, v117 row_mirror row_mask:0xf bank_mask:0xf
    v_add_f32_dpp v118, v118, v118 row_mirror row_mask:0xf bank_mask:0xf
    v_add_f32_dpp v119, v119, v119 row_mirror row_mask:0xf bank_mask:0xf
    v_permlane16_swap_b32 v112, v113
    v_permlane16_swap_b32 v114, v115
    v_add_f32 v112, v112, v113
    v_add_f32 v114, v114, v115
    s_nop 1
    v_permlane32_swap_b32 v112, v114
    s_nop 0
    v_add_f32 v112, v112, v114
    v_permlane16_swap_b32 v116, v117
    v_permlane16_swap_b32 v118, v119
    v_add_f32 v116, v116, v117
    v_add_f32 v118, v118, v119
    s_nop 1
    v_permlane32_swap_b32 v116, v118
    s_nop 0
    v_add_f32 v116, v116, v118
    v_and_b32 v28, 1, v0
    v_cmp_eq_u32 vcc, 1, v28
    s_nop 1
    v_cndmask_b32 v112, v112, v116, vcc
    v_cvt_pk_bf16_f32 v112, v112, v112
    v_lshlrev_b32 v112, 16, v112
    v_mul_f32 v112, 0xbfb8aa3b, v112
    v_exp_f32 v112, v112
    s_nop 0
    v_add_f32 v112, 1.0, v112
    v_rcp_f32 v112, v112
    s_nop 0
    v_cvt_pk_bf16_f32 v112, v112, v112
    v_lshlrev_b32 v112, 16, v112
    v_sub_f32 v113, 1.0, v112
    v_cvt_pk_bf16_f32 v113, v113, v113
    v_lshlrev_b32 v113, 16, v113
    v_lshrrev_b32 v29, 4, v0
    v_lshl_add_u32 v29, v28, 2, v29
    v_lshlrev_b32 v29, 2, v29
    v_and_b32 v30, 15, v0
    v_cmp_gt_u32 vcc, 2, v30
    v_mov_b32 v30, 2147483632
    s_nop 0
    v_cndmask_b32 v29, v30, v29, vcc
    s_lshl_b32 s68, s66, 5
    buffer_store_dword v112, v29, s[56:59], s68 offen sc1
    s_add_u32 s68, s68, 8192
    buffer_store_dword v113, v29, s[56:59], s68 offen sc1
    v_mov_b32 v25, 0
    ds_write_b32 v25, v25
    s_waitcnt vmcnt(0)
    s_waitcnt lgkmcnt(0)
    s_barrier
    s_cmp_lg_u32 s64, 0
    s_cbranch_scc1 L_aux_nog
    s_mov_b32 s71, 0
L_aux_gw:
    v_mov_b32 v12, 0
    buffer_load_dword v12, v12, s[92:95], 0 offen sc1
    s_add_u32 s71, s71, 1
    s_cmp_gt_u32 s71, 200000
    s_cbranch_scc1 L_aux_gok
    s_waitcnt vmcnt(0)
    v_readfirstlane_b32 s68, v12
    s_nop 0
    s_cmp_lg_u32 s68, 1
    s_cbranch_scc1 L_aux_gw
L_aux_gok:
    s_lshl_b32 s68, s2, 7
    s_add_u32 s68, s68, 57344
    buffer_store_dword v11, v10, s[8:11], s68 offen offset:2052 sc1
L_aux_nog:
    global_load_dword v255, v254, s[96:97] sc1
    s_lshl_b32 s68, s66, 13
    buffer_load_dword v64, v9, s[44:47], s68 offen
    s_sub_u32 s68, 255, s66
    s_lshr_b32 s69, s68, 1
    s_lshl_b32 s69, s69, 13
    s_bitcmp1_b32 s68, 0
    s_cselect_b32 s40, s14, s16
    s_cselect_b32 s41, s15, s17
    s_mov_b32 s42, 401408
    buffer_load_dword v65, v9, s[40:43], s69 offen
    s_lshr_b32 s67, s2, 3
    s_lshl_b32 s67, s67, 3
    s_add_u32 s67, s67, s64
    s_lshl_b32 s67, s67, 13
    s_mov_b32 s68, s67
    s_waitcnt vmcnt(1)
    buffer_load_dword v64, v9, s[44:47], s68 offen
    s_add_u32 s68, s68, 262144
    s_waitcnt vmcnt(1)
    buffer_load_dword v65, v9, s[44:47], s68 offen
    s_add_u32 s68, s68, 262144
    global_load_dword v255, v254, s[96:97] sc1
    buffer_load_dword v66, v9, s[44:47], s68 offen
    s_add_u32 s68, s68, 262144
    buffer_load_dword v67, v9, s[44:47], s68 offen
    s_add_u32 s68, s68, 262144
    global_load_dword v255, v254, s[96:97] sc1
    buffer_load_dword v68, v9, s[44:47], s68 offen
    s_add_u32 s68, s68, 262144
    buffer_load_dword v69, v9, s[44:47], s68 offen
    s_add_u32 s68, s68, 262144
    global_load_dword v255, v254, s[96:97] sc1
    buffer_load_dword v70, v9, s[44:47], s68 offen
    s_add_u32 s68, s68, 262144
    buffer_load_dword v72, v9, s[48:51], s67 offen
    buffer_load_dword v73, v9, s[52:55], s67 offen
    s_add_u32 s67, s67, 262144
    buffer_load_dword v74, v9, s[48:51], s67 offen
    buffer_load_dword v75, v9, s[52:55], s67 offen
    s_add_u32 s67, s67, 262144
    global_load_dword v255, v254, s[96:97] sc1
L_end:
    s_endpgm
.section .rodata,"a"
.p2align 6
.amdhsa_kernel gated_mix__ssm_conv_s5__glu_gated_swiglu__prompt_kernel
  .amdhsa_next_free_vgpr 256
  .amdhsa_next_free_sgpr 102
  .amdhsa_accum_offset 256
  .amdhsa_group_segment_fixed_size 0
  .amdhsa_kernarg_size 136
  .amdhsa_user_sgpr_count 2
  .amdhsa_user_sgpr_kernarg_segment_ptr 1
  .amdhsa_system_sgpr_workgroup_id_x 1
.end_amdhsa_kernel
```
